```python
import torch

def _softmax(x, axis=-1):
    return torch.softmax(x, dim=axis)
def _gelu(x):
    return torch.nn.functional.gelu(x, approximate="tanh")
def _silu(x):
    return torch.nn.functional.silu(x)
def _sigmoid(x):
    return torch.sigmoid(x)
def _layernorm(x, axis=-1, eps=1e-5):
    m = x.mean(dim=axis, keepdim=True)
    v = x.var(dim=axis, keepdim=True, unbiased=False)
    return (x - m) / torch.sqrt(v + eps)
def _scatter_add(tgt, idx, src, axis=0):
    return tgt.clone().index_add_(axis, idx, src)
def _segment_sum(src, seg, n):
    out = torch.zeros((n,) + src.shape[1:], dtype=src.dtype)
    return out.index_add_(0, seg, src)
def _pad(x, pw):
    flat = tuple(v for pair in reversed(pw) for v in pair)
    return torch.nn.functional.pad(x, flat)

kernel_name = 'parallel_sum__spectral_fnet__dense_activation_squared_relu__prompt'

def setup_inputs():

    _w = (lambda a: (lambda t: t.to(torch.bfloat16) if t.is_floating_point() else t)(torch.as_tensor(a)))
    def _A_setup():
        B, S, D = 1, 2048, 640
        ns = torch.arange(S)[:, None] * torch.arange(S)[None, :]
        nd = torch.arange(D)[:, None] * torch.arange(D)[None, :]
        Ws_re = torch.cos(-2.0 * torch.pi * ns / S).to(float)
        Ws_im = torch.sin(-2.0 * torch.pi * ns / S).to(float)
        Wd_re = torch.cos(-2.0 * torch.pi * nd / D).to(float)
        Wd_im = torch.sin(-2.0 * torch.pi * nd / D).to(float)
        return {
            "x": _w((lambda *s: torch.randn(*s, dtype=torch.bfloat16) * 0.05)(B, S, D)),
            "dft_seq_re": _w(Ws_re),
            "dft_seq_im": _w(Ws_im),
            "dft_hid_re": _w(Wd_re),
            "dft_hid_im": _w(Wd_im),
        }
    _A_in = _A_setup()

    def _B_setup():
        B, S, D, F = 1, 2048, 640, 1728
        return {
            "x": _w((lambda *s: torch.randn(*s, dtype=torch.bfloat16) * 0.05)(B, S, D)),
            "w1": _w((lambda *s: torch.randn(*s, dtype=torch.bfloat16) * 0.2)(D, F)),
            "b1": _w((lambda *s: torch.randn(*s, dtype=torch.bfloat16) * 0.2)(F)),
            "w2": _w((lambda *s: torch.randn(*s, dtype=torch.bfloat16) * 0.2)(F, D)),
            "b2": _w((lambda *s: torch.randn(*s, dtype=torch.bfloat16) * 0.2)(D)),
        }
    _B_in = _B_setup()

    return {
        "A_x": _A_in["x"],
        "A_dft_seq_re": _A_in["dft_seq_re"],
        "A_dft_seq_im": _A_in["dft_seq_im"],
        "A_dft_hid_re": _A_in["dft_hid_re"],
        "A_dft_hid_im": _A_in["dft_hid_im"],
        "B_x": _B_in["x"],
        "B_w1": _B_in["w1"],
        "B_b1": _B_in["b1"],
        "B_w2": _B_in["w2"],
        "B_b2": _B_in["b2"],
    }

def reference(A_x, A_dft_seq_re, A_dft_seq_im, A_dft_hid_re, A_dft_hid_im, B_x, B_w1, B_b1, B_w2, B_b2):
    def _A_ref(x, dft_seq_re, dft_seq_im, dft_hid_re, dft_hid_im):
        a = torch.einsum("bsd,ed->bse", x, dft_hid_re)
        b = torch.einsum("bsd,ed->bse", x, dft_hid_im)
        y = torch.einsum("ts,bse->bte", dft_seq_re, a) - torch.einsum("ts,bse->bte", dft_seq_im, b)
        return y

    def _B_ref(x, w1, b1, w2, b2):
        h = torch.einsum("bsd,df->bsf", x, w1) + b1
        zero = torch.zeros_like(h)
        r = torch.where(h > zero, h, zero)
        h = r * r
        out = torch.einsum("bsf,fd->bsd", h, w2) + b2
        return out

    x = A_x
    xn = _layernorm(x, axis=-1)
    return x + _A_ref(xn, A_dft_seq_re, A_dft_seq_im, A_dft_hid_re, A_dft_hid_im) + _B_ref(xn, B_w1, B_b1, B_w2, B_b2)
```

```asm
; @launch grid=(256,1,1) block=(512,1,1) lds=163840
.amdgcn_target "amdgcn-amd-amdhsa--gfx950"

.text
.globl parallel_sum__spectral_fnet__dense_activation_squared_relu__prompt_kernel
.p2align 8
.type parallel_sum__spectral_fnet__dense_activation_squared_relu__prompt_kernel,@function
parallel_sum__spectral_fnet__dense_activation_squared_relu__prompt_kernel:
s_cmp_ge_u32 s2, 256
s_cbranch_scc1 L_end
s_getpc_b64 s[18:19]
L_pf:
s_lshr_b32 s21, s2, 3
v_lshlrev_b32 v2, 4, v0
s_lshl_b32 s17, s21, 11
v_add_u32 v2, s17, v2
v_cmp_gt_u32 vcc, 128, v0
s_cmp_lt_u32 s17, L_end - L_pf
s_cselect_b64 vcc, vcc, 0
s_cbranch_vccz L_nopf
global_load_dwordx4 v[252:255], v2, s[18:19]
L_nopf:
s_load_dwordx2 s[4:5], s[0:1], 0
s_load_dwordx2 s[6:7], s[0:1], 48
s_load_dwordx2 s[12:13], s[0:1], 96
s_load_dwordx4 s[8:11], s[0:1], 24
v_lshrrev_b32 v1, 6, v0
s_bfe_u32 s22, s2, 0x20001
v_readfirstlane_b32 s3, v1
s_and_b32 s23, s2, 1
s_lshr_b32 s24, s21, 3
s_and_b32 s25, s21, 7
s_lshl2_add_u32 s26, s22, s24
s_and_b32 s16, s3, 3
s_cmp_ge_u32 s25, 6
s_cselect_b32 s34, 1, 0
s_cmp_lt_u32 s3, 6
s_cbranch_scc1 L_notld
v_and_b32 v0, 63, v0
s_and_b32 s65, s16, 1
v_lshrrev_b32 v11, 3, v0
s_lshl_b32 s17, s65, 3
v_add_u32 v12, s17, v11
s_mov_b32 s18, 81920
v_mul_lo_u32 v2, v12, s18
v_and_b32 v13, 7, v0
v_lshrrev_b32 v14, 4, v0
v_xor_b32 v13, v13, v14
s_lshl_b32 s17, s65, 2
v_xor_b32 v13, s17, v13
v_lshl_add_u32 v2, v13, 4, v2
s_mul_i32 s48, s26, 5120
s_lshl_b32 s55, s65, 10
s_cmp_eq_u32 s34, 1
s_cbranch_scc1 L_ld_D
v_mul_u32_u24 v3, 3456, v14
v_bfe_u32 v13, v0, 2, 2
v_xor_b32 v15, v13, v14
v_lshl_add_u32 v3, v15, 6, v3
v_and_b32 v13, 3, v0
v_lshl_add_u32 v3, v13, 4, v3
v_lshrrev_b32 v14, 2, v0
v_mul_u32_u24 v4, 3456, v14
v_lshl_add_u32 v4, v13, 4, v4
v_and_b32 v13, 32, v0
v_xor_b32 v4, v4, v13
v_xor_b32 v11, 32, v3
s_mul_i32 s49, s65, 55296
s_cmp_eq_u32 s23, 0
s_mov_b32 s28, 0x337ace08
s_cselect_b32 s28, 0x1cc51460, s28
s_cselect_b32 s30, 5, 2
s_mul_i32 s27, s25, 5
s_lshr_b32 s28, s28, s27
s_and_b32 s28, s28, 31
s_lshl_b32 s28, s28, 1
s_bitcmp1_b32 s30, s25
s_cselect_b32 s30, 4, -1
s_add_u32 s30, s30, s28
s_cmp_lt_u32 s25, 3
s_cselect_b32 s33, 1, s34
s_lshl_b32 s52, s30, 6
s_add_u32 s52, s49, s52
s_lshl_b32 s17, s28, 6
s_add_u32 s49, s49, s17
s_add_u32 s64, s24, s25
s_and_b32 s64, s64, 3
s_mov_b32 s56, 0x65742130
s_mov_b32 s57, 0x98
s_cmp_eq_u32 s64, 1
s_cselect_b32 s56, 0x68532410, s56
s_cselect_b32 s57, 0x97, s57
s_cmp_eq_u32 s64, 2
s_cselect_b32 s56, 0x96435201, s56
s_cselect_b32 s57, 0x87, s57
s_cmp_eq_u32 s64, 3
s_cselect_b32 s56, 0x75463102, s56
s_cselect_b32 s57, 0x98, s57
s_lshl_b32 s27, s22, 2
s_lshr_b32 s32, 0x7520, s27
s_and_b32 s32, s32, 15
s_mul_i32 s27, s23, 1
s_add_u32 s32, s32, s27
s_waitcnt lgkmcnt(0)
s_mov_b32 s36, s4
s_mov_b32 s37, s5
s_mov_b32 s38, 2621440
s_mov_b32 s39, 0x20000
s_mov_b32 s44, s12
s_mov_b32 s45, s13
s_mov_b32 s46, 18874368
s_mov_b32 s47, 0x20000
s_load_dword s14, s[12:13], 0
s_mov_b32 s40, s6
s_mov_b32 s41, s7
s_mov_b32 s42, 2211840
s_mov_b32 s43, 0x20000
s_mov_b32 s10, 0
s_cmp_eq_u32 s33, 0
s_cbranch_scc1 L_ld_4
L_ld_5:
s_and_b32 s4, s56, 15
s_lshr_b64 s[56:57], s[56:57], 4
s_add_u32 s4, s4, s32
s_cmp_ge_u32 s4, 10
s_cselect_b32 s27, 10, 0
s_sub_u32 s4, s4, s27
s_lshl_b32 s5, s4, 7
s_add_u32 s5, s5, s48
s_mul_i32 s6, s4, 221184
s_add_u32 s7, s6, s52
s_add_u32 s6, s6, s49
s_add_u32 s8, s10, s55
s_lshl_b32 s9, s55, 2
s_add_u32 s9, s9, s10
s_add_u32 m0, s8, 0
s_nop 0
buffer_load_dwordx4 v2, s[36:39], s5 offen offset:0 lds
s_add_u32 m0, s8, 2816
s_nop 0
buffer_load_dwordx4 v2, s[36:39], s5 offen offset:1280 lds
s_add_u32 m0, s8, 5632
s_nop 0
buffer_load_dwordx4 v2, s[36:39], s5 offen offset:2560 lds
s_add_u32 m0, s8, 8448
s_nop 0
buffer_load_dwordx4 v2, s[36:39], s5 offen offset:3840 lds
s_add_u32 m0, s9, 16384
s_nop 0
buffer_load_dwordx4 v3, s[40:43], s6 offen lds
s_add_u32 m0, s9, 17408
s_add_u32 s6, s6, 13824
buffer_load_dwordx4 v3, s[40:43], s6 offen lds
s_add_u32 m0, s9, 18432
s_add_u32 s6, s6, 13824
buffer_load_dwordx4 v11, s[40:43], s6 offen lds
s_add_u32 m0, s9, 19456
s_add_u32 s6, s6, 13824
buffer_load_dwordx4 v11, s[40:43], s6 offen lds
s_add_u32 m0, s8, 32768
s_nop 0
buffer_load_dwordx4 v4, s[40:43], s7 offen lds
s_add_u32 m0, s8, 2048
s_add_u32 s5, s5, 0x140000
buffer_load_dwordx4 v2, s[36:39], s5 offen offset:0 lds
s_add_u32 m0, s8, 4864
s_nop 0
buffer_load_dwordx4 v2, s[36:39], s5 offen offset:1280 lds
s_add_u32 m0, s8, 7680
s_nop 0
buffer_load_dwordx4 v2, s[36:39], s5 offen offset:2560 lds
s_add_u32 m0, s8, 10496
s_nop 0
buffer_load_dwordx4 v2, s[36:39], s5 offen offset:3840 lds
s_add_u32 m0, s9, 24576
s_add_u32 s6, s6, 69120
buffer_load_dwordx4 v3, s[40:43], s6 offen lds
s_add_u32 m0, s9, 25600
s_add_u32 s6, s6, 13824
buffer_load_dwordx4 v3, s[40:43], s6 offen lds
s_add_u32 m0, s9, 26624
s_add_u32 s6, s6, 13824
buffer_load_dwordx4 v11, s[40:43], s6 offen lds
s_add_u32 m0, s9, 27648
s_add_u32 s6, s6, 13824
buffer_load_dwordx4 v11, s[40:43], s6 offen lds
s_add_u32 m0, s8, 34816
s_add_u32 s7, s7, 110592
buffer_load_dwordx4 v4, s[40:43], s7 offen lds
s_add_u32 s10, s10, 36864
s_cmp_eq_u32 s10, 147456
s_cselect_b32 s10, 0, s10
s_barrier
s_and_b32 s4, s56, 15
s_lshr_b64 s[56:57], s[56:57], 4
s_add_u32 s4, s4, s32
s_cmp_ge_u32 s4, 10
s_cselect_b32 s27, 10, 0
s_sub_u32 s4, s4, s27
s_lshl_b32 s5, s4, 7
s_add_u32 s5, s5, s48
s_mul_i32 s6, s4, 221184
s_add_u32 s7, s6, s52
s_add_u32 s6, s6, s49
s_add_u32 s8, s10, s55
s_lshl_b32 s9, s55, 2
s_add_u32 s9, s9, s10
s_add_u32 m0, s8, 0
s_nop 0
buffer_load_dwordx4 v2, s[36:39], s5 offen offset:0 lds
s_add_u32 m0, s8, 2816
s_nop 0
buffer_load_dwordx4 v2, s[36:39], s5 offen offset:1280 lds
s_add_u32 m0, s8, 5632
s_nop 0
buffer_load_dwordx4 v2, s[36:39], s5 offen offset:2560 lds
s_add_u32 m0, s8, 8448
s_nop 0
buffer_load_dwordx4 v2, s[36:39], s5 offen offset:3840 lds
s_add_u32 m0, s9, 16384
s_nop 0
buffer_load_dwordx4 v3, s[40:43], s6 offen lds
s_add_u32 m0, s9, 17408
s_add_u32 s6, s6, 13824
buffer_load_dwordx4 v3, s[40:43], s6 offen lds
s_add_u32 m0, s9, 18432
s_add_u32 s6, s6, 13824
buffer_load_dwordx4 v11, s[40:43], s6 offen lds
s_add_u32 m0, s9, 19456
s_add_u32 s6, s6, 13824
buffer_load_dwordx4 v11, s[40:43], s6 offen lds
s_add_u32 m0, s8, 32768
s_nop 0
buffer_load_dwordx4 v4, s[40:43], s7 offen lds
s_add_u32 m0, s8, 2048
s_add_u32 s5, s5, 0x140000
buffer_load_dwordx4 v2, s[36:39], s5 offen offset:0 lds
s_add_u32 m0, s8, 4864
s_nop 0
buffer_load_dwordx4 v2, s[36:39], s5 offen offset:1280 lds
s_add_u32 m0, s8, 7680
s_nop 0
buffer_load_dwordx4 v2, s[36:39], s5 offen offset:2560 lds
s_add_u32 m0, s8, 10496
s_nop 0
buffer_load_dwordx4 v2, s[36:39], s5 offen offset:3840 lds
s_add_u32 m0, s9, 24576
s_add_u32 s6, s6, 69120
buffer_load_dwordx4 v3, s[40:43], s6 offen lds
s_add_u32 m0, s9, 25600
s_add_u32 s6, s6, 13824
buffer_load_dwordx4 v3, s[40:43], s6 offen lds
s_add_u32 m0, s9, 26624
s_add_u32 s6, s6, 13824
buffer_load_dwordx4 v11, s[40:43], s6 offen lds
s_add_u32 m0, s9, 27648
s_add_u32 s6, s6, 13824
buffer_load_dwordx4 v11, s[40:43], s6 offen lds
s_add_u32 m0, s8, 34816
s_add_u32 s7, s7, 110592
buffer_load_dwordx4 v4, s[40:43], s7 offen lds
s_add_u32 s10, s10, 36864
s_cmp_eq_u32 s10, 147456
s_cselect_b32 s10, 0, s10
s_lshl3_add_u32 s29, s23, s25
s_and_b32 s15, s21, 3
s_lshl2_add_u32 s15, s23, s15
s_bfe_u32 s31, s21, 0x10002
s_mov_b32 s20, s26
s_lshl1_add_u32 s27, s26, s23
s_mul_i32 s21, s27, 3
s_add_u32 s21, s21, s25
s_add_u32 s21, s21, 61
s_cmp_lt_u32 s25, 3
s_cselect_b32 s17, 99, 0
s_add_u32 s21, s21, s17
s_lshl1_add_u32 s27, s27, s25
s_sub_u32 s27, s27, 6
s_cmp_eq_u32 s34, 1
s_cselect_b32 s21, s27, s21
s_waitcnt lgkmcnt(0)
s_mul_i32 s14, s14, 0x9E3779B1
s_add_u32 s14, s14, 0x85EBCA6B
v_mov_b32 v55, s14
v_lshlrev_b32 v8, 4, v0
v_lshlrev_b32 v7, 2, v0
v_mov_b32 v12, 162816
v_lshlrev_b32 v47, 7, v0
v_mov_b32 v25, 0
s_waitcnt vmcnt(18)
s_barrier
s_and_b32 s4, s56, 15
s_lshr_b64 s[56:57], s[56:57], 4
s_add_u32 s4, s4, s32
s_cmp_ge_u32 s4, 10
s_cselect_b32 s27, 10, 0
s_sub_u32 s4, s4, s27
s_lshl_b32 s5, s4, 7
s_add_u32 s5, s5, s48
s_mul_i32 s6, s4, 221184
s_add_u32 s7, s6, s52
s_add_u32 s6, s6, s49
s_add_u32 s8, s10, s55
s_lshl_b32 s9, s55, 2
s_add_u32 s9, s9, s10
s_add_u32 m0, s8, 0
s_nop 0
buffer_load_dwordx4 v2, s[36:39], s5 offen offset:0 lds
s_add_u32 m0, s8, 2816
s_nop 0
buffer_load_dwordx4 v2, s[36:39], s5 offen offset:1280 lds
s_add_u32 m0, s8, 5632
s_nop 0
buffer_load_dwordx4 v2, s[36:39], s5 offen offset:2560 lds
s_add_u32 m0, s8, 8448
s_nop 0
buffer_load_dwordx4 v2, s[36:39], s5 offen offset:3840 lds
s_add_u32 m0, s9, 16384
s_nop 0
buffer_load_dwordx4 v3, s[40:43], s6 offen lds
s_add_u32 m0, s9, 17408
s_add_u32 s6, s6, 13824
buffer_load_dwordx4 v3, s[40:43], s6 offen lds
s_add_u32 m0, s9, 18432
s_add_u32 s6, s6, 13824
buffer_load_dwordx4 v11, s[40:43], s6 offen lds
s_add_u32 m0, s9, 19456
s_add_u32 s6, s6, 13824
buffer_load_dwordx4 v11, s[40:43], s6 offen lds
s_add_u32 m0, s8, 32768
s_nop 0
buffer_load_dwordx4 v4, s[40:43], s7 offen lds
s_add_u32 m0, s8, 2048
s_add_u32 s5, s5, 0x140000
buffer_load_dwordx4 v2, s[36:39], s5 offen offset:0 lds
s_add_u32 m0, s8, 4864
s_nop 0
buffer_load_dwordx4 v2, s[36:39], s5 offen offset:1280 lds
s_add_u32 m0, s8, 7680
s_nop 0
buffer_load_dwordx4 v2, s[36:39], s5 offen offset:2560 lds
s_add_u32 m0, s8, 10496
s_nop 0
buffer_load_dwordx4 v2, s[36:39], s5 offen offset:3840 lds
s_add_u32 m0, s9, 24576
s_add_u32 s6, s6, 69120
buffer_load_dwordx4 v3, s[40:43], s6 offen lds
s_add_u32 m0, s9, 25600
s_add_u32 s6, s6, 13824
buffer_load_dwordx4 v3, s[40:43], s6 offen lds
s_add_u32 m0, s9, 26624
s_add_u32 s6, s6, 13824
buffer_load_dwordx4 v11, s[40:43], s6 offen lds
s_add_u32 m0, s9, 27648
s_add_u32 s6, s6, 13824
buffer_load_dwordx4 v11, s[40:43], s6 offen lds
s_add_u32 m0, s8, 34816
s_add_u32 s7, s7, 110592
buffer_load_dwordx4 v4, s[40:43], s7 offen lds
s_add_u32 s10, s10, 36864
s_cmp_eq_u32 s10, 147456
s_cselect_b32 s10, 0, s10
s_mov_b32 s11, 1
L_ld_loop5:
s_waitcnt vmcnt(18)
s_barrier
s_and_b32 s4, s56, 15
s_lshr_b64 s[56:57], s[56:57], 4
s_add_u32 s4, s4, s32
s_cmp_ge_u32 s4, 10
s_cselect_b32 s27, 10, 0
s_sub_u32 s4, s4, s27
s_lshl_b32 s5, s4, 7
s_add_u32 s5, s5, s48
s_mul_i32 s6, s4, 221184
s_add_u32 s7, s6, s52
s_add_u32 s6, s6, s49
s_add_u32 s8, s10, s55
s_lshl_b32 s9, s55, 2
s_add_u32 s9, s9, s10
s_add_u32 m0, s8, 0
s_nop 0
buffer_load_dwordx4 v2, s[36:39], s5 offen offset:0 lds
s_add_u32 m0, s8, 2816
s_nop 0
buffer_load_dwordx4 v2, s[36:39], s5 offen offset:1280 lds
s_add_u32 m0, s8, 5632
s_nop 0
buffer_load_dwordx4 v2, s[36:39], s5 offen offset:2560 lds
s_add_u32 m0, s8, 8448
s_nop 0
buffer_load_dwordx4 v2, s[36:39], s5 offen offset:3840 lds
s_add_u32 m0, s9, 16384
s_nop 0
buffer_load_dwordx4 v3, s[40:43], s6 offen lds
s_add_u32 m0, s9, 17408
s_add_u32 s6, s6, 13824
buffer_load_dwordx4 v3, s[40:43], s6 offen lds
s_add_u32 m0, s9, 18432
s_add_u32 s6, s6, 13824
buffer_load_dwordx4 v11, s[40:43], s6 offen lds
s_add_u32 m0, s9, 19456
s_add_u32 s6, s6, 13824
buffer_load_dwordx4 v11, s[40:43], s6 offen lds
s_add_u32 m0, s8, 32768
s_nop 0
buffer_load_dwordx4 v4, s[40:43], s7 offen lds
s_add_u32 m0, s8, 2048
s_add_u32 s5, s5, 0x140000
buffer_load_dwordx4 v2, s[36:39], s5 offen offset:0 lds
s_add_u32 m0, s8, 4864
s_nop 0
buffer_load_dwordx4 v2, s[36:39], s5 offen offset:1280 lds
s_add_u32 m0, s8, 7680
s_nop 0
buffer_load_dwordx4 v2, s[36:39], s5 offen offset:2560 lds
s_add_u32 m0, s8, 10496
s_nop 0
buffer_load_dwordx4 v2, s[36:39], s5 offen offset:3840 lds
s_add_u32 m0, s9, 24576
s_add_u32 s6, s6, 69120
buffer_load_dwordx4 v3, s[40:43], s6 offen lds
s_add_u32 m0, s9, 25600
s_add_u32 s6, s6, 13824
buffer_load_dwordx4 v3, s[40:43], s6 offen lds
s_add_u32 m0, s9, 26624
s_add_u32 s6, s6, 13824
buffer_load_dwordx4 v11, s[40:43], s6 offen lds
s_add_u32 m0, s9, 27648
s_add_u32 s6, s6, 13824
buffer_load_dwordx4 v11, s[40:43], s6 offen lds
s_add_u32 m0, s8, 34816
s_add_u32 s7, s7, 110592
buffer_load_dwordx4 v4, s[40:43], s7 offen lds
s_add_u32 s10, s10, 36864
s_cmp_eq_u32 s10, 147456
s_cselect_b32 s10, 0, s10
s_add_u32 s11, s11, 1
s_cmp_lt_u32 s11, 8
s_cbranch_scc1 L_ld_loop5
s_waitcnt vmcnt(18)
s_barrier
s_waitcnt vmcnt(0)
s_barrier
s_branch L_ld_w
L_ld_4:
s_and_b32 s4, s56, 15
s_lshr_b64 s[56:57], s[56:57], 4
s_add_u32 s4, s4, s32
s_cmp_ge_u32 s4, 10
s_cselect_b32 s27, 10, 0
s_sub_u32 s4, s4, s27
s_lshl_b32 s5, s4, 7
s_add_u32 s5, s5, s48
s_mul_i32 s6, s4, 221184
s_add_u32 s7, s6, s52
s_add_u32 s6, s6, s49
s_add_u32 s8, s10, s55
s_lshl_b32 s9, s55, 2
s_add_u32 s9, s9, s10
s_add_u32 m0, s8, 0
s_nop 0
buffer_load_dwordx4 v2, s[36:39], s5 offen offset:0 lds
s_add_u32 m0, s8, 2816
s_nop 0
buffer_load_dwordx4 v2, s[36:39], s5 offen offset:1280 lds
s_add_u32 m0, s8, 5632
s_nop 0
buffer_load_dwordx4 v2, s[36:39], s5 offen offset:2560 lds
s_add_u32 m0, s8, 8448
s_nop 0
buffer_load_dwordx4 v2, s[36:39], s5 offen offset:3840 lds
s_add_u32 m0, s9, 16384
s_nop 0
buffer_load_dwordx4 v3, s[40:43], s6 offen lds
s_add_u32 m0, s9, 17408
s_add_u32 s6, s6, 13824
buffer_load_dwordx4 v3, s[40:43], s6 offen lds
s_add_u32 m0, s9, 18432
s_add_u32 s6, s6, 13824
buffer_load_dwordx4 v11, s[40:43], s6 offen lds
s_add_u32 m0, s9, 19456
s_add_u32 s6, s6, 13824
buffer_load_dwordx4 v11, s[40:43], s6 offen lds
s_add_u32 m0, s8, 2048
s_add_u32 s5, s5, 0x140000
buffer_load_dwordx4 v2, s[36:39], s5 offen offset:0 lds
s_add_u32 m0, s8, 4864
s_nop 0
buffer_load_dwordx4 v2, s[36:39], s5 offen offset:1280 lds
s_add_u32 m0, s8, 7680
s_nop 0
buffer_load_dwordx4 v2, s[36:39], s5 offen offset:2560 lds
s_add_u32 m0, s8, 10496
s_nop 0
buffer_load_dwordx4 v2, s[36:39], s5 offen offset:3840 lds
s_add_u32 m0, s9, 24576
s_add_u32 s6, s6, 69120
buffer_load_dwordx4 v3, s[40:43], s6 offen lds
s_add_u32 m0, s9, 25600
s_add_u32 s6, s6, 13824
buffer_load_dwordx4 v3, s[40:43], s6 offen lds
s_add_u32 m0, s9, 26624
s_add_u32 s6, s6, 13824
buffer_load_dwordx4 v11, s[40:43], s6 offen lds
s_add_u32 m0, s9, 27648
s_add_u32 s6, s6, 13824
buffer_load_dwordx4 v11, s[40:43], s6 offen lds
s_add_u32 s10, s10, 36864
s_cmp_eq_u32 s10, 147456
s_cselect_b32 s10, 0, s10
s_barrier
s_and_b32 s4, s56, 15
s_lshr_b64 s[56:57], s[56:57], 4
s_add_u32 s4, s4, s32
s_cmp_ge_u32 s4, 10
s_cselect_b32 s27, 10, 0
s_sub_u32 s4, s4, s27
s_lshl_b32 s5, s4, 7
s_add_u32 s5, s5, s48
s_mul_i32 s6, s4, 221184
s_add_u32 s7, s6, s52
s_add_u32 s6, s6, s49
s_add_u32 s8, s10, s55
s_lshl_b32 s9, s55, 2
s_add_u32 s9, s9, s10
s_add_u32 m0, s8, 0
s_nop 0
buffer_load_dwordx4 v2, s[36:39], s5 offen offset:0 lds
s_add_u32 m0, s8, 2816
s_nop 0
buffer_load_dwordx4 v2, s[36:39], s5 offen offset:1280 lds
s_add_u32 m0, s8, 5632
s_nop 0
buffer_load_dwordx4 v2, s[36:39], s5 offen offset:2560 lds
s_add_u32 m0, s8, 8448
s_nop 0
buffer_load_dwordx4 v2, s[36:39], s5 offen offset:3840 lds
s_add_u32 m0, s9, 16384
s_nop 0
buffer_load_dwordx4 v3, s[40:43], s6 offen lds
s_add_u32 m0, s9, 17408
s_add_u32 s6, s6, 13824
buffer_load_dwordx4 v3, s[40:43], s6 offen lds
s_add_u32 m0, s9, 18432
s_add_u32 s6, s6, 13824
buffer_load_dwordx4 v11, s[40:43], s6 offen lds
s_add_u32 m0, s9, 19456
s_add_u32 s6, s6, 13824
buffer_load_dwordx4 v11, s[40:43], s6 offen lds
s_add_u32 m0, s8, 2048
s_add_u32 s5, s5, 0x140000
buffer_load_dwordx4 v2, s[36:39], s5 offen offset:0 lds
s_add_u32 m0, s8, 4864
s_nop 0
buffer_load_dwordx4 v2, s[36:39], s5 offen offset:1280 lds
s_add_u32 m0, s8, 7680
s_nop 0
buffer_load_dwordx4 v2, s[36:39], s5 offen offset:2560 lds
s_add_u32 m0, s8, 10496
s_nop 0
buffer_load_dwordx4 v2, s[36:39], s5 offen offset:3840 lds
s_add_u32 m0, s9, 24576
s_add_u32 s6, s6, 69120
buffer_load_dwordx4 v3, s[40:43], s6 offen lds
s_add_u32 m0, s9, 25600
s_add_u32 s6, s6, 13824
buffer_load_dwordx4 v3, s[40:43], s6 offen lds
s_add_u32 m0, s9, 26624
s_add_u32 s6, s6, 13824
buffer_load_dwordx4 v11, s[40:43], s6 offen lds
s_add_u32 m0, s9, 27648
s_add_u32 s6, s6, 13824
buffer_load_dwordx4 v11, s[40:43], s6 offen lds
s_add_u32 s10, s10, 36864
s_cmp_eq_u32 s10, 147456
s_cselect_b32 s10, 0, s10
s_lshl3_add_u32 s29, s23, s25
s_and_b32 s15, s21, 3
s_lshl2_add_u32 s15, s23, s15
s_bfe_u32 s31, s21, 0x10002
s_mov_b32 s20, s26
s_lshl1_add_u32 s27, s26, s23
s_mul_i32 s21, s27, 3
s_add_u32 s21, s21, s25
s_add_u32 s21, s21, 61
s_cmp_lt_u32 s25, 3
s_cselect_b32 s17, 99, 0
s_add_u32 s21, s21, s17
s_lshl1_add_u32 s27, s27, s25
s_sub_u32 s27, s27, 6
s_cmp_eq_u32 s34, 1
s_cselect_b32 s21, s27, s21
s_waitcnt lgkmcnt(0)
s_mul_i32 s14, s14, 0x9E3779B1
s_add_u32 s14, s14, 0x85EBCA6B
v_mov_b32 v55, s14
v_lshlrev_b32 v8, 4, v0
v_lshlrev_b32 v7, 2, v0
v_mov_b32 v12, 162816
v_lshlrev_b32 v47, 7, v0
v_mov_b32 v25, 0
s_waitcnt vmcnt(16)
s_barrier
s_and_b32 s4, s56, 15
s_lshr_b64 s[56:57], s[56:57], 4
s_add_u32 s4, s4, s32
s_cmp_ge_u32 s4, 10
s_cselect_b32 s27, 10, 0
s_sub_u32 s4, s4, s27
s_lshl_b32 s5, s4, 7
s_add_u32 s5, s5, s48
s_mul_i32 s6, s4, 221184
s_add_u32 s7, s6, s52
s_add_u32 s6, s6, s49
s_add_u32 s8, s10, s55
s_lshl_b32 s9, s55, 2
s_add_u32 s9, s9, s10
s_add_u32 m0, s8, 0
s_nop 0
buffer_load_dwordx4 v2, s[36:39], s5 offen offset:0 lds
s_add_u32 m0, s8, 2816
s_nop 0
buffer_load_dwordx4 v2, s[36:39], s5 offen offset:1280 lds
s_add_u32 m0, s8, 5632
s_nop 0
buffer_load_dwordx4 v2, s[36:39], s5 offen offset:2560 lds
s_add_u32 m0, s8, 8448
s_nop 0
buffer_load_dwordx4 v2, s[36:39], s5 offen offset:3840 lds
s_add_u32 m0, s9, 16384
s_nop 0
buffer_load_dwordx4 v3, s[40:43], s6 offen lds
s_add_u32 m0, s9, 17408
s_add_u32 s6, s6, 13824
buffer_load_dwordx4 v3, s[40:43], s6 offen lds
s_add_u32 m0, s9, 18432
s_add_u32 s6, s6, 13824
buffer_load_dwordx4 v11, s[40:43], s6 offen lds
s_add_u32 m0, s9, 19456
s_add_u32 s6, s6, 13824
buffer_load_dwordx4 v11, s[40:43], s6 offen lds
s_add_u32 m0, s8, 2048
s_add_u32 s5, s5, 0x140000
buffer_load_dwordx4 v2, s[36:39], s5 offen offset:0 lds
s_add_u32 m0, s8, 4864
s_nop 0
buffer_load_dwordx4 v2, s[36:39], s5 offen offset:1280 lds
s_add_u32 m0, s8, 7680
s_nop 0
buffer_load_dwordx4 v2, s[36:39], s5 offen offset:2560 lds
s_add_u32 m0, s8, 10496
s_nop 0
buffer_load_dwordx4 v2, s[36:39], s5 offen offset:3840 lds
s_add_u32 m0, s9, 24576
s_add_u32 s6, s6, 69120
buffer_load_dwordx4 v3, s[40:43], s6 offen lds
s_add_u32 m0, s9, 25600
s_add_u32 s6, s6, 13824
buffer_load_dwordx4 v3, s[40:43], s6 offen lds
s_add_u32 m0, s9, 26624
s_add_u32 s6, s6, 13824
buffer_load_dwordx4 v11, s[40:43], s6 offen lds
s_add_u32 m0, s9, 27648
s_add_u32 s6, s6, 13824
buffer_load_dwordx4 v11, s[40:43], s6 offen lds
s_add_u32 s10, s10, 36864
s_cmp_eq_u32 s10, 147456
s_cselect_b32 s10, 0, s10
s_cmp_eq_u32 s2, 24
s_cbranch_scc0 L_ld_nc
v_add_u32 v20, 114688, v8
s_and_b32 s17, s16, 1
s_lshl_b32 s18, s17, 13
v_add_u32 v21, s18, v20
s_lshl_b32 s18, s17, 11
v_add_u32 v22, s18, v20
ds_read_b128 v[108:111], v20 offset:0
ds_read_b128 v[124:127], v20 offset:1024
ds_read_b128 v[112:115], v20 offset:2048
ds_read_b128 v[128:131], v20 offset:3072
ds_read_b128 v[116:119], v20 offset:4096
ds_read_b128 v[132:135], v20 offset:5120
ds_read_b128 v[120:123], v20 offset:6144
ds_read_b128 v[136:139], v20 offset:7168
ds_read_b128 v[76:79], v21 offset:8192
ds_read_b128 v[92:95], v21 offset:12288
ds_read_b128 v[80:83], v21 offset:9216
ds_read_b128 v[96:99], v21 offset:13312
ds_read_b128 v[84:87], v21 offset:10240
ds_read_b128 v[100:103], v21 offset:14336
ds_read_b128 v[88:91], v21 offset:11264
ds_read_b128 v[104:107], v21 offset:15360
ds_read_b128 v[64:67], v22 offset:24576
ds_read_b128 v[68:71], v22 offset:25600
s_waitcnt lgkmcnt(0)
L_ld_nc:
s_mov_b32 s11, 1
L_ld_loop4:
s_waitcnt vmcnt(16)
s_barrier
s_and_b32 s4, s56, 15
s_lshr_b64 s[56:57], s[56:57], 4
s_add_u32 s4, s4, s32
s_cmp_ge_u32 s4, 10
s_cselect_b32 s27, 10, 0
s_sub_u32 s4, s4, s27
s_lshl_b32 s5, s4, 7
s_add_u32 s5, s5, s48
s_mul_i32 s6, s4, 221184
s_add_u32 s7, s6, s52
s_add_u32 s6, s6, s49
s_add_u32 s8, s10, s55
s_lshl_b32 s9, s55, 2
s_add_u32 s9, s9, s10
s_add_u32 m0, s8, 0
s_nop 0
buffer_load_dwordx4 v2, s[36:39], s5 offen offset:0 lds
s_add_u32 m0, s8, 2816
s_nop 0
buffer_load_dwordx4 v2, s[36:39], s5 offen offset:1280 lds
s_add_u32 m0, s8, 5632
s_nop 0
buffer_load_dwordx4 v2, s[36:39], s5 offen offset:2560 lds
s_add_u32 m0, s8, 8448
s_nop 0
buffer_load_dwordx4 v2, s[36:39], s5 offen offset:3840 lds
s_add_u32 m0, s9, 16384
s_nop 0
buffer_load_dwordx4 v3, s[40:43], s6 offen lds
s_add_u32 m0, s9, 17408
s_add_u32 s6, s6, 13824
buffer_load_dwordx4 v3, s[40:43], s6 offen lds
s_add_u32 m0, s9, 18432
s_add_u32 s6, s6, 13824
buffer_load_dwordx4 v11, s[40:43], s6 offen lds
s_add_u32 m0, s9, 19456
s_add_u32 s6, s6, 13824
buffer_load_dwordx4 v11, s[40:43], s6 offen lds
s_add_u32 m0, s8, 2048
s_add_u32 s5, s5, 0x140000
buffer_load_dwordx4 v2, s[36:39], s5 offen offset:0 lds
s_add_u32 m0, s8, 4864
s_nop 0
buffer_load_dwordx4 v2, s[36:39], s5 offen offset:1280 lds
s_add_u32 m0, s8, 7680
s_nop 0
buffer_load_dwordx4 v2, s[36:39], s5 offen offset:2560 lds
s_add_u32 m0, s8, 10496
s_nop 0
buffer_load_dwordx4 v2, s[36:39], s5 offen offset:3840 lds
s_add_u32 m0, s9, 24576
s_add_u32 s6, s6, 69120
buffer_load_dwordx4 v3, s[40:43], s6 offen lds
s_add_u32 m0, s9, 25600
s_add_u32 s6, s6, 13824
buffer_load_dwordx4 v3, s[40:43], s6 offen lds
s_add_u32 m0, s9, 26624
s_add_u32 s6, s6, 13824
buffer_load_dwordx4 v11, s[40:43], s6 offen lds
s_add_u32 m0, s9, 27648
s_add_u32 s6, s6, 13824
buffer_load_dwordx4 v11, s[40:43], s6 offen lds
s_add_u32 s10, s10, 36864
s_cmp_eq_u32 s10, 147456
s_cselect_b32 s10, 0, s10
s_add_u32 s11, s11, 1
s_cmp_lt_u32 s11, 8
s_cbranch_scc1 L_ld_loop4
s_waitcnt vmcnt(16)
s_barrier
s_waitcnt vmcnt(0)
s_barrier
L_ld_w:
s_lshl_b32 s18, s16, 3
s_lshr_b32 s17, 0x2f282018, s18
s_and_b32 s17, s17, 0xff
s_add_u32 s17, s17, 1
s_mul_i32 s8, s17, 40960
s_mul_i32 s17, s15, 5120
s_add_u32 s8, s8, s17
s_add_u32 s8, s8, 1048576
s_mul_i32 s7, s16, 35840
s_cmp_ge_u32 s16, 2
s_cselect_b32 s27, 2048, 0
s_add_u32 s7, s7, s27
s_cmp_eq_u32 s16, 3
s_cselect_b32 s7, 104448, s7
s_lshl_b32 s17, s24, 1
s_add_u32 s17, s17, s31
s_cmp_ge_u32 s17, 6
s_cselect_b32 s18, 6, 0
s_sub_u32 s17, s17, s18
s_sub_u32 s6, 6, s17
s_mul_i32 s4, s17, 5120
s_add_u32 s4, s4, s7
s_mul_i32 s5, s17, 40960
s_add_u32 s5, s5, s8
s_mov_b32 s18, 6
L_l_dmaa:
s_mov_b32 m0, s4
s_add_u32 s17, s5, 4096
buffer_load_dwordx4 v8, s[44:47], s5 offen offset:0 sc1 lds
buffer_load_dwordx4 v8, s[44:47], s5 offen offset:1024 sc1 lds
buffer_load_dwordx4 v8, s[44:47], s5 offen offset:2048 sc1 lds
buffer_load_dwordx4 v8, s[44:47], s5 offen offset:3072 sc1 lds
s_add_u32 m0, s4, 4096
s_add_u32 s4, s4, 5120
buffer_load_dwordx4 v8, s[44:47], s17 offen sc1 lds
s_add_u32 s5, s5, 40960
s_sub_u32 s6, s6, 1
s_cmp_eq_u32 s6, 0
s_cselect_b32 s4, s7, s4
s_cselect_b32 s5, s8, s5
s_sub_u32 s18, s18, 1
s_cmp_lg_u32 s18, 0
s_cbranch_scc1 L_l_dmaa
s_mov_b32 s19, 0
L_sp1:
ds_read_b32 v16, v12 offset:76
s_waitcnt lgkmcnt(0)
v_readfirstlane_b32 s27, v16
s_add_u32 s19, s19, 1
s_cmp_gt_u32 s19, 200000
s_cbranch_scc1 L_sp1d
s_cmp_ge_u32 s27, 4
s_cbranch_scc1 L_sp1d
s_sleep 1
s_branch L_sp1
L_sp1d:
s_xor_b32 s9, s16, 2
s_lshl_b32 s18, s9, 3
s_lshr_b32 s17, 0x2f282018, s18
s_and_b32 s17, s17, 0xff
s_add_u32 s17, s17, 1
s_mul_i32 s8, s17, 40960
s_mul_i32 s17, s15, 5120
s_add_u32 s8, s8, s17
s_add_u32 s8, s8, 1048576
s_mul_i32 s7, s9, 35840
s_cmp_ge_u32 s9, 2
s_cselect_b32 s27, 2048, 0
s_add_u32 s7, s7, s27
s_cmp_eq_u32 s9, 3
s_cselect_b32 s7, 104448, s7
s_lshl_b32 s17, s24, 1
s_add_u32 s17, s17, s31
s_cmp_ge_u32 s17, 7
s_cselect_b32 s18, 7, 0
s_sub_u32 s17, s17, s18
s_sub_u32 s6, 7, s17
s_mul_i32 s4, s17, 5120
s_add_u32 s4, s4, s7
s_mul_i32 s5, s17, 40960
s_add_u32 s5, s5, s8
s_mov_b32 s18, 1
L_l_dmabp:
s_mov_b32 m0, s4
s_add_u32 s17, s5, 4096
buffer_load_dwordx4 v8, s[44:47], s5 offen offset:0 sc1 lds
buffer_load_dwordx4 v8, s[44:47], s5 offen offset:1024 sc1 lds
buffer_load_dwordx4 v8, s[44:47], s5 offen offset:2048 sc1 lds
buffer_load_dwordx4 v8, s[44:47], s5 offen offset:3072 sc1 lds
s_add_u32 m0, s4, 4096
s_add_u32 s4, s4, 5120
buffer_load_dwordx4 v8, s[44:47], s17 offen sc1 lds
s_add_u32 s5, s5, 40960
s_sub_u32 s6, s6, 1
s_cmp_eq_u32 s6, 0
s_cselect_b32 s4, s7, s4
s_cselect_b32 s5, s8, s5
s_sub_u32 s18, s18, 1
s_cmp_lg_u32 s18, 0
s_cbranch_scc1 L_l_dmabp
s_mov_b32 s19, 0
L_sp2:
ds_read_b32 v16, v12 offset:64
s_waitcnt lgkmcnt(0)
v_readfirstlane_b32 s27, v16
s_add_u32 s19, s19, 1
s_cmp_gt_u32 s19, 200000
s_cbranch_scc1 L_sp2d
s_cmp_ge_u32 s27, 1
s_cbranch_scc1 L_sp2d
s_sleep 1
s_branch L_sp2
L_sp2d:
s_mov_b32 s18, 3
L_l_dmacq:
s_mov_b32 m0, s4
s_add_u32 s17, s5, 4096
buffer_load_dwordx4 v8, s[44:47], s5 offen offset:0 sc1 lds
buffer_load_dwordx4 v8, s[44:47], s5 offen offset:1024 sc1 lds
buffer_load_dwordx4 v8, s[44:47], s5 offen offset:2048 sc1 lds
buffer_load_dwordx4 v8, s[44:47], s5 offen offset:3072 sc1 lds
s_add_u32 m0, s4, 4096
s_add_u32 s4, s4, 5120
buffer_load_dwordx4 v8, s[44:47], s17 offen sc1 lds
s_add_u32 s5, s5, 40960
s_sub_u32 s6, s6, 1
s_cmp_eq_u32 s6, 0
s_cselect_b32 s4, s7, s4
s_cselect_b32 s5, s8, s5
s_sub_u32 s18, s18, 1
s_cmp_lg_u32 s18, 0
s_cbranch_scc1 L_l_dmacq
s_cmp_eq_u32 s16, 3
s_cbranch_scc0 L_l_g25
v_lshlrev_b32 v47, 7, v0
s_lshl_b32 s0, s20, 11
s_add_u32 s0, s0, 294912
s_mov_b64 exec, 0x0707
buffer_load_dword v56, v47, s[44:47], s0 offen sc1
s_mov_b64 exec, -1
L_l_g25:
s_mov_b32 s18, 3
L_l_dmacg:
s_mov_b32 m0, s4
s_add_u32 s17, s5, 4096
buffer_load_dwordx4 v8, s[44:47], s5 offen offset:0 sc1 lds
buffer_load_dwordx4 v8, s[44:47], s5 offen offset:1024 sc1 lds
buffer_load_dwordx4 v8, s[44:47], s5 offen offset:2048 sc1 lds
buffer_load_dwordx4 v8, s[44:47], s5 offen offset:3072 sc1 lds
s_add_u32 m0, s4, 4096
s_add_u32 s4, s4, 5120
buffer_load_dwordx4 v8, s[44:47], s17 offen sc1 lds
s_add_u32 s5, s5, 40960
s_sub_u32 s6, s6, 1
s_cmp_eq_u32 s6, 0
s_cselect_b32 s4, s7, s4
s_cselect_b32 s5, s8, s5
s_sub_u32 s18, s18, 1
s_cmp_lg_u32 s18, 0
s_cbranch_scc1 L_l_dmacg
s_cmp_eq_u32 s16, 3
s_cbranch_scc0 L_l_g24
s_waitcnt vmcnt(15)
s_mov_b32 s19, 0
s_branch L_po3c
L_po3:
s_mov_b64 exec, 0x0707
buffer_load_dword v56, v47, s[44:47], s0 offen sc1
s_waitcnt vmcnt(0)
L_po3c:
s_mov_b64 exec, 0x0707
v_cmp_ne_u32 vcc, v55, v56
s_mov_b64 exec, -1
s_add_u32 s19, s19, 1
s_cmp_gt_u32 s19, 200000
s_cbranch_scc1 L_po3d
s_cbranch_vccz L_po3d
s_sleep 8
s_branch L_po3
L_po3d:
v_mov_b32 v16, 1
ds_write_b32 v12, v16 offset:72
L_l_g24:
s_cmp_eq_u32 s2, 24
s_cbranch_scc0 L_l_fft
s_mov_b32 s17, 0x80000000
s_mov_b32 s18, 0x80008000
v_xor_b32 v140, s17, v108
v_xor_b32 v141, s17, v109
v_xor_b32 v142, s17, v110
v_xor_b32 v143, s17, v111
v_xor_b32 v144, s17, v112
v_xor_b32 v145, s17, v113
v_xor_b32 v146, s17, v114
v_xor_b32 v147, s17, v115
v_xor_b32 v148, s17, v116
v_xor_b32 v149, s17, v117
v_xor_b32 v150, s17, v118
v_xor_b32 v151, s17, v119
v_xor_b32 v152, s17, v120
v_xor_b32 v153, s17, v121
v_xor_b32 v154, s17, v122
v_xor_b32 v155, s17, v123
v_xor_b32 v156, s17, v124
v_xor_b32 v157, s17, v125
v_xor_b32 v158, s17, v126
v_xor_b32 v159, s17, v127
v_xor_b32 v160, s17, v128
v_xor_b32 v161, s17, v129
v_xor_b32 v162, s17, v130
v_xor_b32 v163, s17, v131
v_xor_b32 v164, s17, v132
v_xor_b32 v165, s17, v133
v_xor_b32 v166, s17, v134
v_xor_b32 v167, s17, v135
v_xor_b32 v168, s17, v136
v_xor_b32 v169, s17, v137
v_xor_b32 v170, s17, v138
v_xor_b32 v171, s17, v139
v_xor_b32 v72, s18, v68
v_xor_b32 v73, s18, v69
v_xor_b32 v74, s18, v70
v_xor_b32 v75, s18, v71
s_branch L_l_fft
L_ld_D:
s_mov_b32 s33, 1
v_mul_u32_u24 v11, 2560, v11
v_lshl_add_u32 v3, v13, 4, v11
s_and_b32 s17, s25, 1
s_mul_i32 s17, s17, 1280
s_mul_i32 s49, s65, 20480
s_add_u32 s49, s49, s17
s_add_u32 s56, s24, s22
s_cmp_ge_u32 s56, 5
s_cselect_b32 s17, 5, 0
s_sub_u32 s56, s56, s17
s_waitcnt lgkmcnt(0)
s_mov_b32 s36, s4
s_mov_b32 s37, s5
s_mov_b32 s38, 2621440
s_mov_b32 s39, 0x20000
s_mov_b32 s44, s12
s_mov_b32 s45, s13
s_mov_b32 s46, 18874368
s_mov_b32 s47, 0x20000
s_load_dword s14, s[12:13], 0
s_cmp_eq_u32 s23, 0
s_cselect_b32 s40, s8, s10
s_cselect_b32 s41, s9, s11
s_mov_b32 s42, 819200
s_mov_b32 s43, 0x20000
s_mov_b32 s10, 0
s_lshl_b32 s4, s56, 7
s_add_u32 s5, s4, s48
s_add_u32 s6, s4, s49
s_add_u32 s8, s10, s55
s_add_u32 m0, s8, 0
s_nop 0
buffer_load_dwordx4 v2, s[36:39], s5 offen offset:0 lds
s_add_u32 m0, s8, 2816
s_nop 0
buffer_load_dwordx4 v2, s[36:39], s5 offen offset:1280 lds
s_add_u32 m0, s8, 5632
s_nop 0
buffer_load_dwordx4 v2, s[36:39], s5 offen offset:2560 lds
s_add_u32 m0, s8, 8448
s_nop 0
buffer_load_dwordx4 v2, s[36:39], s5 offen offset:3840 lds
s_add_u32 m0, s8, 2048
s_add_u32 s5, s5, 0x140000
buffer_load_dwordx4 v2, s[36:39], s5 offen offset:0 lds
s_add_u32 m0, s8, 4864
s_nop 0
buffer_load_dwordx4 v2, s[36:39], s5 offen offset:1280 lds
s_add_u32 m0, s8, 7680
s_nop 0
buffer_load_dwordx4 v2, s[36:39], s5 offen offset:2560 lds
s_add_u32 m0, s8, 10496
s_nop 0
buffer_load_dwordx4 v2, s[36:39], s5 offen offset:3840 lds
s_add_u32 m0, s8, 16384
s_nop 0
buffer_load_dwordx4 v3, s[40:43], s6 offen lds
s_add_u32 m0, s8, 18432
s_add_u32 s6, s6, 40960
buffer_load_dwordx4 v3, s[40:43], s6 offen lds
s_add_u32 m0, s8, 20480
s_add_u32 s6, s6, 40960
buffer_load_dwordx4 v3, s[40:43], s6 offen lds
s_add_u32 m0, s8, 22528
s_add_u32 s6, s6, 40960
buffer_load_dwordx4 v3, s[40:43], s6 offen lds
s_add_u32 m0, s8, 24576
s_add_u32 s6, s6, 40960
buffer_load_dwordx4 v3, s[40:43], s6 offen lds
s_add_u32 m0, s8, 26624
s_add_u32 s6, s6, 40960
buffer_load_dwordx4 v3, s[40:43], s6 offen lds
s_add_u32 s10, s10, 28672
s_cmp_eq_u32 s10, 143360
s_cselect_b32 s10, 0, s10
s_barrier
s_lshl_b32 s4, s56, 7
s_add_u32 s5, s4, s48
s_add_u32 s6, s4, s49
s_add_u32 s8, s10, s55
s_add_u32 s5, s5, 640
s_add_u32 s6, s6, 245760
s_add_u32 s56, s56, 1
s_cmp_eq_u32 s56, 5
s_cselect_b32 s56, 0, s56
s_add_u32 m0, s8, 0
s_nop 0
buffer_load_dwordx4 v2, s[36:39], s5 offen offset:0 lds
s_add_u32 m0, s8, 2816
s_nop 0
buffer_load_dwordx4 v2, s[36:39], s5 offen offset:1280 lds
s_add_u32 m0, s8, 5632
s_nop 0
buffer_load_dwordx4 v2, s[36:39], s5 offen offset:2560 lds
s_add_u32 m0, s8, 8448
s_nop 0
buffer_load_dwordx4 v2, s[36:39], s5 offen offset:3840 lds
s_add_u32 m0, s8, 2048
s_add_u32 s5, s5, 0x140000
buffer_load_dwordx4 v2, s[36:39], s5 offen offset:0 lds
s_add_u32 m0, s8, 4864
s_nop 0
buffer_load_dwordx4 v2, s[36:39], s5 offen offset:1280 lds
s_add_u32 m0, s8, 7680
s_nop 0
buffer_load_dwordx4 v2, s[36:39], s5 offen offset:2560 lds
s_add_u32 m0, s8, 10496
s_nop 0
buffer_load_dwordx4 v2, s[36:39], s5 offen offset:3840 lds
s_add_u32 m0, s8, 16384
s_nop 0
buffer_load_dwordx4 v3, s[40:43], s6 offen lds
s_add_u32 m0, s8, 18432
s_add_u32 s6, s6, 40960
buffer_load_dwordx4 v3, s[40:43], s6 offen lds
s_add_u32 m0, s8, 20480
s_add_u32 s6, s6, 40960
buffer_load_dwordx4 v3, s[40:43], s6 offen lds
s_add_u32 m0, s8, 22528
s_add_u32 s6, s6, 40960
buffer_load_dwordx4 v3, s[40:43], s6 offen lds
s_add_u32 s10, s10, 28672
s_cmp_eq_u32 s10, 143360
s_cselect_b32 s10, 0, s10
s_lshl_b32 s4, s56, 7
s_add_u32 s5, s4, s48
s_add_u32 s6, s4, s49
s_add_u32 s8, s10, s55
s_add_u32 m0, s8, 0
s_nop 0
buffer_load_dwordx4 v2, s[36:39], s5 offen offset:0 lds
s_add_u32 m0, s8, 2816
s_nop 0
buffer_load_dwordx4 v2, s[36:39], s5 offen offset:1280 lds
s_add_u32 m0, s8, 5632
s_nop 0
buffer_load_dwordx4 v2, s[36:39], s5 offen offset:2560 lds
s_add_u32 m0, s8, 8448
s_nop 0
buffer_load_dwordx4 v2, s[36:39], s5 offen offset:3840 lds
s_add_u32 m0, s8, 2048
s_add_u32 s5, s5, 0x140000
buffer_load_dwordx4 v2, s[36:39], s5 offen offset:0 lds
s_add_u32 m0, s8, 4864
s_nop 0
buffer_load_dwordx4 v2, s[36:39], s5 offen offset:1280 lds
s_add_u32 m0, s8, 7680
s_nop 0
buffer_load_dwordx4 v2, s[36:39], s5 offen offset:2560 lds
s_add_u32 m0, s8, 10496
s_nop 0
buffer_load_dwordx4 v2, s[36:39], s5 offen offset:3840 lds
s_add_u32 m0, s8, 16384
s_nop 0
buffer_load_dwordx4 v3, s[40:43], s6 offen lds
s_add_u32 m0, s8, 18432
s_add_u32 s6, s6, 40960
buffer_load_dwordx4 v3, s[40:43], s6 offen lds
s_add_u32 m0, s8, 20480
s_add_u32 s6, s6, 40960
buffer_load_dwordx4 v3, s[40:43], s6 offen lds
s_add_u32 m0, s8, 22528
s_add_u32 s6, s6, 40960
buffer_load_dwordx4 v3, s[40:43], s6 offen lds
s_add_u32 m0, s8, 24576
s_add_u32 s6, s6, 40960
buffer_load_dwordx4 v3, s[40:43], s6 offen lds
s_add_u32 m0, s8, 26624
s_add_u32 s6, s6, 40960
buffer_load_dwordx4 v3, s[40:43], s6 offen lds
s_add_u32 s10, s10, 28672
s_cmp_eq_u32 s10, 143360
s_cselect_b32 s10, 0, s10
s_lshl3_add_u32 s29, s23, s25
s_and_b32 s15, s21, 3
s_lshl2_add_u32 s15, s23, s15
s_bfe_u32 s31, s21, 0x10002
s_mov_b32 s20, s26
s_lshl1_add_u32 s27, s26, s23
s_mul_i32 s21, s27, 3
s_add_u32 s21, s21, s25
s_add_u32 s21, s21, 61
s_cmp_lt_u32 s25, 3
s_cselect_b32 s17, 99, 0
s_add_u32 s21, s21, s17
s_lshl1_add_u32 s27, s27, s25
s_sub_u32 s27, s27, 6
s_cmp_eq_u32 s34, 1
s_cselect_b32 s21, s27, s21
s_waitcnt lgkmcnt(0)
s_mul_i32 s14, s14, 0x9E3779B1
s_add_u32 s14, s14, 0x85EBCA6B
v_mov_b32 v55, s14
v_lshlrev_b32 v8, 4, v0
v_lshlrev_b32 v7, 2, v0
v_mov_b32 v12, 162816
v_lshlrev_b32 v47, 7, v0
v_mov_b32 v25, 0
s_waitcnt vmcnt(14)
s_barrier
s_lshl_b32 s4, s56, 7
s_add_u32 s5, s4, s48
s_add_u32 s6, s4, s49
s_add_u32 s8, s10, s55
s_add_u32 s5, s5, 640
s_add_u32 s6, s6, 245760
s_add_u32 s56, s56, 1
s_cmp_eq_u32 s56, 5
s_cselect_b32 s56, 0, s56
s_add_u32 m0, s8, 0
s_nop 0
buffer_load_dwordx4 v2, s[36:39], s5 offen offset:0 lds
s_add_u32 m0, s8, 2816
s_nop 0
buffer_load_dwordx4 v2, s[36:39], s5 offen offset:1280 lds
s_add_u32 m0, s8, 5632
s_nop 0
buffer_load_dwordx4 v2, s[36:39], s5 offen offset:2560 lds
s_add_u32 m0, s8, 8448
s_nop 0
buffer_load_dwordx4 v2, s[36:39], s5 offen offset:3840 lds
s_add_u32 m0, s8, 2048
s_add_u32 s5, s5, 0x140000
buffer_load_dwordx4 v2, s[36:39], s5 offen offset:0 lds
s_add_u32 m0, s8, 4864
s_nop 0
buffer_load_dwordx4 v2, s[36:39], s5 offen offset:1280 lds
s_add_u32 m0, s8, 7680
s_nop 0
buffer_load_dwordx4 v2, s[36:39], s5 offen offset:2560 lds
s_add_u32 m0, s8, 10496
s_nop 0
buffer_load_dwordx4 v2, s[36:39], s5 offen offset:3840 lds
s_add_u32 m0, s8, 16384
s_nop 0
buffer_load_dwordx4 v3, s[40:43], s6 offen lds
s_add_u32 m0, s8, 18432
s_add_u32 s6, s6, 40960
buffer_load_dwordx4 v3, s[40:43], s6 offen lds
s_add_u32 m0, s8, 20480
s_add_u32 s6, s6, 40960
buffer_load_dwordx4 v3, s[40:43], s6 offen lds
s_add_u32 m0, s8, 22528
s_add_u32 s6, s6, 40960
buffer_load_dwordx4 v3, s[40:43], s6 offen lds
s_add_u32 s10, s10, 28672
s_cmp_eq_u32 s10, 143360
s_cselect_b32 s10, 0, s10
v_add_u32 v20, 114688, v8
s_and_b32 s17, s16, 1
s_lshl_b32 s18, s17, 13
v_add_u32 v21, s18, v20
s_lshl_b32 s18, s17, 11
v_add_u32 v22, s18, v20
ds_read_b128 v[108:111], v20 offset:0
ds_read_b128 v[124:127], v20 offset:1024
ds_read_b128 v[112:115], v20 offset:2048
ds_read_b128 v[128:131], v20 offset:3072
ds_read_b128 v[116:119], v20 offset:4096
ds_read_b128 v[132:135], v20 offset:5120
ds_read_b128 v[120:123], v20 offset:6144
ds_read_b128 v[136:139], v20 offset:7168
ds_read_b128 v[76:79], v21 offset:8192
ds_read_b128 v[92:95], v21 offset:12288
ds_read_b128 v[80:83], v21 offset:9216
ds_read_b128 v[96:99], v21 offset:13312
ds_read_b128 v[84:87], v21 offset:10240
ds_read_b128 v[100:103], v21 offset:14336
ds_read_b128 v[88:91], v21 offset:11264
ds_read_b128 v[104:107], v21 offset:15360
ds_read_b128 v[64:67], v22 offset:24576
ds_read_b128 v[68:71], v22 offset:25600
s_waitcnt lgkmcnt(0)
s_barrier
s_lshl_b32 s4, s56, 7
s_add_u32 s5, s4, s48
s_add_u32 s6, s4, s49
s_add_u32 s8, s10, s55
s_add_u32 m0, s8, 0
s_nop 0
buffer_load_dwordx4 v2, s[36:39], s5 offen offset:0 lds
s_add_u32 m0, s8, 2816
s_nop 0
buffer_load_dwordx4 v2, s[36:39], s5 offen offset:1280 lds
s_add_u32 m0, s8, 5632
s_nop 0
buffer_load_dwordx4 v2, s[36:39], s5 offen offset:2560 lds
s_add_u32 m0, s8, 8448
s_nop 0
buffer_load_dwordx4 v2, s[36:39], s5 offen offset:3840 lds
s_add_u32 m0, s8, 2048
s_add_u32 s5, s5, 0x140000
buffer_load_dwordx4 v2, s[36:39], s5 offen offset:0 lds
s_add_u32 m0, s8, 4864
s_nop 0
buffer_load_dwordx4 v2, s[36:39], s5 offen offset:1280 lds
s_add_u32 m0, s8, 7680
s_nop 0
buffer_load_dwordx4 v2, s[36:39], s5 offen offset:2560 lds
s_add_u32 m0, s8, 10496
s_nop 0
buffer_load_dwordx4 v2, s[36:39], s5 offen offset:3840 lds
s_add_u32 m0, s8, 16384
s_nop 0
buffer_load_dwordx4 v3, s[40:43], s6 offen lds
s_add_u32 m0, s8, 18432
s_add_u32 s6, s6, 40960
buffer_load_dwordx4 v3, s[40:43], s6 offen lds
s_add_u32 m0, s8, 20480
s_add_u32 s6, s6, 40960
buffer_load_dwordx4 v3, s[40:43], s6 offen lds
s_add_u32 m0, s8, 22528
s_add_u32 s6, s6, 40960
buffer_load_dwordx4 v3, s[40:43], s6 offen lds
s_add_u32 m0, s8, 24576
s_add_u32 s6, s6, 40960
buffer_load_dwordx4 v3, s[40:43], s6 offen lds
s_add_u32 m0, s8, 26624
s_add_u32 s6, s6, 40960
buffer_load_dwordx4 v3, s[40:43], s6 offen lds
s_add_u32 s10, s10, 28672
s_cmp_eq_u32 s10, 143360
s_cselect_b32 s10, 0, s10
s_waitcnt vmcnt(14)
s_barrier
s_lshl_b32 s4, s56, 7
s_add_u32 s5, s4, s48
s_add_u32 s6, s4, s49
s_add_u32 s8, s10, s55
s_add_u32 s5, s5, 640
s_add_u32 s6, s6, 245760
s_add_u32 s56, s56, 1
s_cmp_eq_u32 s56, 5
s_cselect_b32 s56, 0, s56
s_add_u32 m0, s8, 0
s_nop 0
buffer_load_dwordx4 v2, s[36:39], s5 offen offset:0 lds
s_add_u32 m0, s8, 2816
s_nop 0
buffer_load_dwordx4 v2, s[36:39], s5 offen offset:1280 lds
s_add_u32 m0, s8, 5632
s_nop 0
buffer_load_dwordx4 v2, s[36:39], s5 offen offset:2560 lds
s_add_u32 m0, s8, 8448
s_nop 0
buffer_load_dwordx4 v2, s[36:39], s5 offen offset:3840 lds
s_add_u32 m0, s8, 2048
s_add_u32 s5, s5, 0x140000
buffer_load_dwordx4 v2, s[36:39], s5 offen offset:0 lds
s_add_u32 m0, s8, 4864
s_nop 0
buffer_load_dwordx4 v2, s[36:39], s5 offen offset:1280 lds
s_add_u32 m0, s8, 7680
s_nop 0
buffer_load_dwordx4 v2, s[36:39], s5 offen offset:2560 lds
s_add_u32 m0, s8, 10496
s_nop 0
buffer_load_dwordx4 v2, s[36:39], s5 offen offset:3840 lds
s_add_u32 m0, s8, 16384
s_nop 0
buffer_load_dwordx4 v3, s[40:43], s6 offen lds
s_add_u32 m0, s8, 18432
s_add_u32 s6, s6, 40960
buffer_load_dwordx4 v3, s[40:43], s6 offen lds
s_add_u32 m0, s8, 20480
s_add_u32 s6, s6, 40960
buffer_load_dwordx4 v3, s[40:43], s6 offen lds
s_add_u32 m0, s8, 22528
s_add_u32 s6, s6, 40960
buffer_load_dwordx4 v3, s[40:43], s6 offen lds
s_add_u32 s10, s10, 28672
s_cmp_eq_u32 s10, 143360
s_cselect_b32 s10, 0, s10
s_lshl_b32 s4, s56, 7
s_add_u32 s5, s4, s48
s_add_u32 s6, s4, s49
s_add_u32 s8, s10, s55
s_add_u32 m0, s8, 0
s_nop 0
buffer_load_dwordx4 v2, s[36:39], s5 offen offset:0 lds
s_add_u32 m0, s8, 2816
s_nop 0
buffer_load_dwordx4 v2, s[36:39], s5 offen offset:1280 lds
s_add_u32 m0, s8, 5632
s_nop 0
buffer_load_dwordx4 v2, s[36:39], s5 offen offset:2560 lds
s_add_u32 m0, s8, 8448
s_nop 0
buffer_load_dwordx4 v2, s[36:39], s5 offen offset:3840 lds
s_add_u32 m0, s8, 2048
s_add_u32 s5, s5, 0x140000
buffer_load_dwordx4 v2, s[36:39], s5 offen offset:0 lds
s_add_u32 m0, s8, 4864
s_nop 0
buffer_load_dwordx4 v2, s[36:39], s5 offen offset:1280 lds
s_add_u32 m0, s8, 7680
s_nop 0
buffer_load_dwordx4 v2, s[36:39], s5 offen offset:2560 lds
s_add_u32 m0, s8, 10496
s_nop 0
buffer_load_dwordx4 v2, s[36:39], s5 offen offset:3840 lds
s_add_u32 m0, s8, 16384
s_nop 0
buffer_load_dwordx4 v3, s[40:43], s6 offen lds
s_add_u32 m0, s8, 18432
s_add_u32 s6, s6, 40960
buffer_load_dwordx4 v3, s[40:43], s6 offen lds
s_add_u32 m0, s8, 20480
s_add_u32 s6, s6, 40960
buffer_load_dwordx4 v3, s[40:43], s6 offen lds
s_add_u32 m0, s8, 22528
s_add_u32 s6, s6, 40960
buffer_load_dwordx4 v3, s[40:43], s6 offen lds
s_add_u32 m0, s8, 24576
s_add_u32 s6, s6, 40960
buffer_load_dwordx4 v3, s[40:43], s6 offen lds
s_add_u32 m0, s8, 26624
s_add_u32 s6, s6, 40960
buffer_load_dwordx4 v3, s[40:43], s6 offen lds
s_add_u32 s10, s10, 28672
s_cmp_eq_u32 s10, 143360
s_cselect_b32 s10, 0, s10
s_waitcnt vmcnt(14)
s_barrier
s_lshl_b32 s4, s56, 7
s_add_u32 s5, s4, s48
s_add_u32 s6, s4, s49
s_add_u32 s8, s10, s55
s_add_u32 s5, s5, 640
s_add_u32 s6, s6, 245760
s_add_u32 s56, s56, 1
s_cmp_eq_u32 s56, 5
s_cselect_b32 s56, 0, s56
s_add_u32 m0, s8, 0
s_nop 0
buffer_load_dwordx4 v2, s[36:39], s5 offen offset:0 lds
s_add_u32 m0, s8, 2816
s_nop 0
buffer_load_dwordx4 v2, s[36:39], s5 offen offset:1280 lds
s_add_u32 m0, s8, 5632
s_nop 0
buffer_load_dwordx4 v2, s[36:39], s5 offen offset:2560 lds
s_add_u32 m0, s8, 8448
s_nop 0
buffer_load_dwordx4 v2, s[36:39], s5 offen offset:3840 lds
s_add_u32 m0, s8, 2048
s_add_u32 s5, s5, 0x140000
buffer_load_dwordx4 v2, s[36:39], s5 offen offset:0 lds
s_add_u32 m0, s8, 4864
s_nop 0
buffer_load_dwordx4 v2, s[36:39], s5 offen offset:1280 lds
s_add_u32 m0, s8, 7680
s_nop 0
buffer_load_dwordx4 v2, s[36:39], s5 offen offset:2560 lds
s_add_u32 m0, s8, 10496
s_nop 0
buffer_load_dwordx4 v2, s[36:39], s5 offen offset:3840 lds
s_add_u32 m0, s8, 16384
s_nop 0
buffer_load_dwordx4 v3, s[40:43], s6 offen lds
s_add_u32 m0, s8, 18432
s_add_u32 s6, s6, 40960
buffer_load_dwordx4 v3, s[40:43], s6 offen lds
s_add_u32 m0, s8, 20480
s_add_u32 s6, s6, 40960
buffer_load_dwordx4 v3, s[40:43], s6 offen lds
s_add_u32 m0, s8, 22528
s_add_u32 s6, s6, 40960
buffer_load_dwordx4 v3, s[40:43], s6 offen lds
s_add_u32 s10, s10, 28672
s_cmp_eq_u32 s10, 143360
s_cselect_b32 s10, 0, s10
s_lshl_b32 s4, s56, 7
s_add_u32 s5, s4, s48
s_add_u32 s6, s4, s49
s_add_u32 s8, s10, s55
s_add_u32 m0, s8, 0
s_nop 0
buffer_load_dwordx4 v2, s[36:39], s5 offen offset:0 lds
s_add_u32 m0, s8, 2816
s_nop 0
buffer_load_dwordx4 v2, s[36:39], s5 offen offset:1280 lds
s_add_u32 m0, s8, 5632
s_nop 0
buffer_load_dwordx4 v2, s[36:39], s5 offen offset:2560 lds
s_add_u32 m0, s8, 8448
s_nop 0
buffer_load_dwordx4 v2, s[36:39], s5 offen offset:3840 lds
s_add_u32 m0, s8, 2048
s_add_u32 s5, s5, 0x140000
buffer_load_dwordx4 v2, s[36:39], s5 offen offset:0 lds
s_add_u32 m0, s8, 4864
s_nop 0
buffer_load_dwordx4 v2, s[36:39], s5 offen offset:1280 lds
s_add_u32 m0, s8, 7680
s_nop 0
buffer_load_dwordx4 v2, s[36:39], s5 offen offset:2560 lds
s_add_u32 m0, s8, 10496
s_nop 0
buffer_load_dwordx4 v2, s[36:39], s5 offen offset:3840 lds
s_add_u32 m0, s8, 16384
s_nop 0
buffer_load_dwordx4 v3, s[40:43], s6 offen lds
s_add_u32 m0, s8, 18432
s_add_u32 s6, s6, 40960
buffer_load_dwordx4 v3, s[40:43], s6 offen lds
s_add_u32 m0, s8, 20480
s_add_u32 s6, s6, 40960
buffer_load_dwordx4 v3, s[40:43], s6 offen lds
s_add_u32 m0, s8, 22528
s_add_u32 s6, s6, 40960
buffer_load_dwordx4 v3, s[40:43], s6 offen lds
s_add_u32 m0, s8, 24576
s_add_u32 s6, s6, 40960
buffer_load_dwordx4 v3, s[40:43], s6 offen lds
s_add_u32 m0, s8, 26624
s_add_u32 s6, s6, 40960
buffer_load_dwordx4 v3, s[40:43], s6 offen lds
s_add_u32 s10, s10, 28672
s_cmp_eq_u32 s10, 143360
s_cselect_b32 s10, 0, s10
s_waitcnt vmcnt(14)
s_barrier
s_lshl_b32 s4, s56, 7
s_add_u32 s5, s4, s48
s_add_u32 s6, s4, s49
s_add_u32 s8, s10, s55
s_add_u32 s5, s5, 640
s_add_u32 s6, s6, 245760
s_add_u32 s56, s56, 1
s_cmp_eq_u32 s56, 5
s_cselect_b32 s56, 0, s56
s_add_u32 m0, s8, 0
s_nop 0
buffer_load_dwordx4 v2, s[36:39], s5 offen offset:0 lds
s_add_u32 m0, s8, 2816
s_nop 0
buffer_load_dwordx4 v2, s[36:39], s5 offen offset:1280 lds
s_add_u32 m0, s8, 5632
s_nop 0
buffer_load_dwordx4 v2, s[36:39], s5 offen offset:2560 lds
s_add_u32 m0, s8, 8448
s_nop 0
buffer_load_dwordx4 v2, s[36:39], s5 offen offset:3840 lds
s_add_u32 m0, s8, 2048
s_add_u32 s5, s5, 0x140000
buffer_load_dwordx4 v2, s[36:39], s5 offen offset:0 lds
s_add_u32 m0, s8, 4864
s_nop 0
buffer_load_dwordx4 v2, s[36:39], s5 offen offset:1280 lds
s_add_u32 m0, s8, 7680
s_nop 0
buffer_load_dwordx4 v2, s[36:39], s5 offen offset:2560 lds
s_add_u32 m0, s8, 10496
s_nop 0
buffer_load_dwordx4 v2, s[36:39], s5 offen offset:3840 lds
s_add_u32 m0, s8, 16384
s_nop 0
buffer_load_dwordx4 v3, s[40:43], s6 offen lds
s_add_u32 m0, s8, 18432
s_add_u32 s6, s6, 40960
buffer_load_dwordx4 v3, s[40:43], s6 offen lds
s_add_u32 m0, s8, 20480
s_add_u32 s6, s6, 40960
buffer_load_dwordx4 v3, s[40:43], s6 offen lds
s_add_u32 m0, s8, 22528
s_add_u32 s6, s6, 40960
buffer_load_dwordx4 v3, s[40:43], s6 offen lds
s_add_u32 s10, s10, 28672
s_cmp_eq_u32 s10, 143360
s_cselect_b32 s10, 0, s10
s_waitcnt vmcnt(0)
s_barrier
s_xor_b32 s9, s16, 2
s_lshl_b32 s18, s9, 3
s_lshr_b32 s17, 0x2f282018, s18
s_and_b32 s17, s17, 0xff
s_add_u32 s17, s17, 1
s_mul_i32 s8, s17, 40960
s_mul_i32 s17, s15, 5120
s_add_u32 s8, s8, s17
s_add_u32 s8, s8, 1048576
s_mul_i32 s7, s9, 35840
s_cmp_ge_u32 s9, 2
s_cselect_b32 s27, 2048, 0
s_add_u32 s7, s7, s27
s_cmp_eq_u32 s9, 3
s_cselect_b32 s7, 104448, s7
s_lshl_b32 s17, s24, 1
s_add_u32 s17, s17, s31
s_cmp_ge_u32 s17, 7
s_cselect_b32 s18, 7, 0
s_sub_u32 s17, s17, s18
s_sub_u32 s6, 7, s17
s_mul_i32 s4, s17, 5120
s_add_u32 s4, s4, s7
s_mul_i32 s5, s17, 40960
s_add_u32 s5, s5, s8
s_mov_b32 s18, 5
L_l_dmabd:
s_mov_b32 m0, s4
s_add_u32 s17, s5, 4096
buffer_load_dwordx4 v8, s[44:47], s5 offen offset:0 sc1 lds
buffer_load_dwordx4 v8, s[44:47], s5 offen offset:1024 sc1 lds
buffer_load_dwordx4 v8, s[44:47], s5 offen offset:2048 sc1 lds
buffer_load_dwordx4 v8, s[44:47], s5 offen offset:3072 sc1 lds
s_add_u32 m0, s4, 4096
s_add_u32 s4, s4, 5120
buffer_load_dwordx4 v8, s[44:47], s17 offen sc1 lds
s_add_u32 s5, s5, 40960
s_sub_u32 s6, s6, 1
s_cmp_eq_u32 s6, 0
s_cselect_b32 s4, s7, s4
s_cselect_b32 s5, s8, s5
s_sub_u32 s18, s18, 1
s_cmp_lg_u32 s18, 0
s_cbranch_scc1 L_l_dmabd
s_setprio 3
s_mov_b32 s17, 0x80000000
s_mov_b32 s18, 0x80008000
v_xor_b32 v140, s17, v108
v_xor_b32 v141, s17, v109
v_xor_b32 v142, s17, v110
v_xor_b32 v143, s17, v111
v_xor_b32 v144, s17, v112
v_xor_b32 v145, s17, v113
v_xor_b32 v146, s17, v114
v_xor_b32 v147, s17, v115
v_xor_b32 v148, s17, v116
v_xor_b32 v149, s17, v117
v_xor_b32 v150, s17, v118
v_xor_b32 v151, s17, v119
v_xor_b32 v152, s17, v120
v_xor_b32 v153, s17, v121
v_xor_b32 v154, s17, v122
v_xor_b32 v155, s17, v123
v_xor_b32 v156, s17, v124
v_xor_b32 v157, s17, v125
v_xor_b32 v158, s17, v126
v_xor_b32 v159, s17, v127
v_xor_b32 v160, s17, v128
v_xor_b32 v161, s17, v129
v_xor_b32 v162, s17, v130
v_xor_b32 v163, s17, v131
v_xor_b32 v164, s17, v132
v_xor_b32 v165, s17, v133
v_xor_b32 v166, s17, v134
v_xor_b32 v167, s17, v135
v_xor_b32 v168, s17, v136
v_xor_b32 v169, s17, v137
v_xor_b32 v170, s17, v138
v_xor_b32 v171, s17, v139
v_xor_b32 v72, s18, v68
v_xor_b32 v73, s18, v69
v_xor_b32 v74, s18, v70
v_xor_b32 v75, s18, v71
s_mov_b32 s19, 0
L_sp4:
ds_read_b32 v16, v12 offset:64
s_waitcnt lgkmcnt(0)
v_readfirstlane_b32 s27, v16
s_add_u32 s19, s19, 1
s_cmp_gt_u32 s19, 200000
s_cbranch_scc1 L_sp4d
s_cmp_ge_u32 s27, 1
s_cbranch_scc1 L_sp4d
s_sleep 1
s_branch L_sp4
L_sp4d:
s_mov_b32 s18, 2
L_l_dmacf:
s_mov_b32 m0, s4
s_add_u32 s17, s5, 4096
buffer_load_dwordx4 v8, s[44:47], s5 offen offset:0 sc1 lds
buffer_load_dwordx4 v8, s[44:47], s5 offen offset:1024 sc1 lds
buffer_load_dwordx4 v8, s[44:47], s5 offen offset:2048 sc1 lds
buffer_load_dwordx4 v8, s[44:47], s5 offen offset:3072 sc1 lds
s_add_u32 m0, s4, 4096
s_add_u32 s4, s4, 5120
buffer_load_dwordx4 v8, s[44:47], s17 offen sc1 lds
s_add_u32 s5, s5, 40960
s_sub_u32 s6, s6, 1
s_cmp_eq_u32 s6, 0
s_cselect_b32 s4, s7, s4
s_cselect_b32 s5, s8, s5
s_sub_u32 s18, s18, 1
s_cmp_lg_u32 s18, 0
s_cbranch_scc1 L_l_dmacf
s_branch L_l_fft
L_notld:
s_load_dwordx2 s[62:63], s[0:1], 56
s_load_dwordx4 s[80:83], s[0:1], 64
s_load_dwordx2 s[84:85], s[0:1], 80
v_and_b32 v0, 63, v0
s_cmp_lt_u32 s3, 4
s_cbranch_scc1 L_gstart
s_cmp_eq_u32 s23, 0
s_mov_b32 s28, 0x337ace08
s_cselect_b32 s28, 0x1cc51460, s28
s_cselect_b32 s30, 5, 2
s_mul_i32 s27, s25, 5
s_lshr_b32 s28, s28, s27
s_and_b32 s28, s28, 31
s_lshl_b32 s28, s28, 1
s_bitcmp1_b32 s30, s25
s_cselect_b32 s30, 4, -1
s_add_u32 s30, s30, s28
s_cmp_lt_u32 s25, 3
s_cselect_b32 s33, 1, s34
s_lshl3_add_u32 s29, s23, s25
s_and_b32 s15, s21, 3
s_lshl2_add_u32 s15, s23, s15
s_bfe_u32 s31, s21, 0x10002
s_mov_b32 s20, s26
s_lshl1_add_u32 s27, s26, s23
s_mul_i32 s21, s27, 3
s_add_u32 s21, s21, s25
s_add_u32 s21, s21, 61
s_cmp_lt_u32 s25, 3
s_cselect_b32 s17, 99, 0
s_add_u32 s21, s21, s17
s_lshl1_add_u32 s27, s27, s25
s_sub_u32 s27, s27, 6
s_cmp_eq_u32 s34, 1
s_cselect_b32 s21, s27, s21
L_hp:
v_lshlrev_b32 v7, 2, v0
v_add_u32 v9, 162816, v7
v_mov_b32 v8, 0
ds_write_b32 v9, v8
s_waitcnt lgkmcnt(0)
s_mov_b32 s36, s4
s_mov_b32 s37, s5
s_mov_b32 s38, 2621440
s_mov_b32 s39, 0x20000
s_mov_b32 s44, s12
s_mov_b32 s45, s13
s_mov_b32 s46, 18874368
s_mov_b32 s47, 0x20000
s_load_dword s14, s[12:13], 0
s_mov_b32 s76, s62
s_mov_b32 s77, s63
s_mov_b32 s78, 3456
s_mov_b32 s79, 0x20000
v_lshlrev_b32 v8, 4, v0
v_lshlrev_b32 v7, 2, v0
v_and_b32 v9, 7, v0
v_lshlrev_b32 v9, 2, v9
v_and_b32 v10, 32, v0
v_add_u32 v9, v9, v10
s_add_u32 s17, s28, s16
s_lshl_b32 s17, s17, 6
s_lshl_b32 s18, s30, 6
s_cmp_eq_u32 s34, 1
s_cselect_b32 s17, 0x40000000, s17
s_cselect_b32 s18, 0x40000000, s18
buffer_load_dword v13, v9, s[76:79], s17 offen
buffer_load_dword v14, v9, s[76:79], s17 offen offset:128
buffer_load_dword v15, v9, s[76:79], s18 offen
s_mov_b32 s72, s82
s_mov_b32 s73, s83
s_mov_b32 s74, 1280
s_mov_b32 s75, 0x20000
s_mul_i32 s5, s15, 160
s_lshl_b32 s17, s16, 6
v_add_u32 v20, s17, v0
v_add_u32 v20, 0, v20
v_mul_u32_u24 v21, 6554, v20
v_lshrrev_b32 v21, 16, v21
v_mul_u32_u24 v22, 10, v21
v_sub_u32 v22, v20, v22
v_lshlrev_b32 v27, 4, v22
buffer_load_dwordx4 v[176:179], v27, s[72:75], s5 offen
v_lshlrev_b32 v22, 1, v22
v_bfe_u32 v23, v21, 1, 2
v_xor_b32 v22, v22, v23
v_mul_u32_u24 v23, 320, v21
v_lshl_add_u32 v22, v22, 4, v23
v_add_u32 v245, 135168, v22
v_and_b32 v23, 15, v21
v_mul_u32_u24 v23, 0x14000, v23
v_lshrrev_b32 v21, 4, v21
v_mul_u32_u24 v21, 1280, v21
v_add3_u32 v240, v23, v21, v27
v_add_u32 v20, s17, v0
v_add_u32 v20, 128, v20
v_mul_u32_u24 v21, 6554, v20
v_lshrrev_b32 v21, 16, v21
v_mul_u32_u24 v22, 10, v21
v_sub_u32 v22, v20, v22
v_lshlrev_b32 v27, 4, v22
buffer_load_dwordx4 v[184:187], v27, s[72:75], s5 offen
v_lshlrev_b32 v22, 1, v22
v_bfe_u32 v23, v21, 1, 2
v_xor_b32 v22, v22, v23
v_mul_u32_u24 v23, 320, v21
v_lshl_add_u32 v22, v22, 4, v23
v_add_u32 v246, 135168, v22
v_and_b32 v23, 15, v21
v_mul_u32_u24 v23, 0x14000, v23
v_lshrrev_b32 v21, 4, v21
v_mul_u32_u24 v21, 1280, v21
v_add3_u32 v241, v23, v21, v27
v_add_u32 v20, s17, v0
v_add_u32 v20, 256, v20
v_mul_u32_u24 v21, 6554, v20
v_lshrrev_b32 v21, 16, v21
v_mul_u32_u24 v22, 10, v21
v_sub_u32 v22, v20, v22
v_lshlrev_b32 v27, 4, v22
buffer_load_dwordx4 v[192:195], v27, s[72:75], s5 offen
v_lshlrev_b32 v22, 1, v22
v_bfe_u32 v23, v21, 1, 2
v_xor_b32 v22, v22, v23
v_mul_u32_u24 v23, 320, v21
v_lshl_add_u32 v22, v22, 4, v23
v_add_u32 v247, 135168, v22
v_and_b32 v23, 15, v21
v_mul_u32_u24 v23, 0x14000, v23
v_lshrrev_b32 v21, 4, v21
v_mul_u32_u24 v21, 1280, v21
v_add3_u32 v242, v23, v21, v27
v_add_u32 v20, s17, v0
v_add_u32 v20, 384, v20
v_mul_u32_u24 v21, 6554, v20
v_lshrrev_b32 v21, 16, v21
v_mul_u32_u24 v22, 10, v21
v_sub_u32 v22, v20, v22
v_lshlrev_b32 v27, 4, v22
buffer_load_dwordx4 v[200:203], v27, s[72:75], s5 offen
v_lshlrev_b32 v22, 1, v22
v_bfe_u32 v23, v21, 1, 2
v_xor_b32 v22, v22, v23
v_mul_u32_u24 v23, 320, v21
v_lshl_add_u32 v22, v22, 4, v23
v_add_u32 v248, 135168, v22
v_and_b32 v23, 15, v21
v_mul_u32_u24 v23, 0x14000, v23
v_lshrrev_b32 v21, 4, v21
v_mul_u32_u24 v21, 1280, v21
v_add3_u32 v243, v23, v21, v27
v_add_u32 v20, s17, v0
v_add_u32 v20, 512, v20
v_mul_u32_u24 v21, 6554, v20
v_lshrrev_b32 v21, 16, v21
v_mul_u32_u24 v22, 10, v21
v_sub_u32 v22, v20, v22
v_lshlrev_b32 v27, 4, v22
buffer_load_dwordx4 v[208:211], v27, s[72:75], s5 offen
v_lshlrev_b32 v22, 1, v22
v_bfe_u32 v23, v21, 1, 2
v_xor_b32 v22, v22, v23
v_mul_u32_u24 v23, 320, v21
v_lshl_add_u32 v22, v22, 4, v23
v_add_u32 v249, 135168, v22
v_and_b32 v23, 15, v21
v_mul_u32_u24 v23, 0x14000, v23
v_lshrrev_b32 v21, 4, v21
v_mul_u32_u24 v21, 1280, v21
v_add3_u32 v244, v23, v21, v27
s_mul_i32 s60, s21, 6554
s_lshr_b32 s60, s60, 16
s_mul_i32 s18, s60, 10
s_sub_u32 s61, s21, s18
s_mul_i32 s0, s16, 25
s_add_u32 s0, s0, s60
s_mul_i32 s0, s0, 10
s_add_u32 s0, s0, s61
v_lshrrev_b32 v5, 3, v0
v_mul_u32_u24 v5, 1280, v5
v_and_b32 v6, 7, v0
v_lshl_add_u32 v5, v6, 4, v5
s_mul_i32 s17, s0, 6554
s_lshr_b32 s17, s17, 16
s_mul_i32 s18, s17, 10
s_sub_u32 s18, s0, s18
s_mul_i32 s48, s17, 40960
s_cmp_lt_u32 s17, 42
s_cselect_b32 s27, 12, -30
s_cmp_lt_u32 s17, 32
s_cselect_b32 s27, -20, s27
s_cmp_lt_u32 s17, 20
s_cselect_b32 s27, 24, s27
s_add_u32 s17, s17, s27
s_mul_i32 s51, s17, 40960
s_lshl_b32 s17, s18, 12
s_add_u32 s51, s51, s17
s_add_u32 s51, s51, 1048576
s_lshl_b32 s17, s18, 7
s_add_u32 s48, s48, s17
s_cmp_ge_u32 s60, 25
s_cselect_b32 s48, 0x40000000, s48
s_cselect_b32 s51, 0x40000000, s51
s_mov_b32 s50, 147456
s_cmp_eq_u32 s34, 1
s_cselect_b32 s50, 143360, s50
s_lshl_b32 s17, s16, 12
s_add_u32 s50, s50, s17
s_mov_b32 s76, s80
s_mov_b32 s77, s81
s_mov_b32 s78, 2211840
s_mov_b32 s79, 0x20000
s_lshl_b32 s17, s16, 8
s_or_b32 s17, s17, s21
s_cmp_lt_u32 s17, 40
s_cselect_b32 s62, 1, 0
s_cbranch_scc0 L_hp_n3
s_add_u32 s0, s21, 500
v_lshrrev_b32 v5, 3, v0
v_mul_u32_u24 v5, 1280, v5
v_and_b32 v6, 7, v0
v_lshl_add_u32 v5, v6, 4, v5
s_mul_i32 s17, s0, 6554
s_lshr_b32 s17, s17, 16
s_mul_i32 s18, s17, 10
s_sub_u32 s18, s0, s18
s_mul_i32 s49, s17, 40960
s_cmp_lt_u32 s17, 42
s_cselect_b32 s27, 12, -30
s_cmp_lt_u32 s17, 32
s_cselect_b32 s27, -20, s27
s_cmp_lt_u32 s17, 20
s_cselect_b32 s27, 24, s27
s_add_u32 s17, s17, s27
s_mul_i32 s53, s17, 40960
s_lshl_b32 s17, s18, 12
s_add_u32 s53, s53, s17
s_add_u32 s53, s53, 1048576
s_lshl_b32 s17, s18, 7
s_add_u32 s49, s49, s17
s_mov_b32 s52, 151552
L_hp_n3:
s_add_u32 s64, s24, s25
s_and_b32 s64, s64, 3
s_mov_b32 s56, 0x65742130
s_mov_b32 s57, 0x98
s_cmp_eq_u32 s64, 1
s_cselect_b32 s56, 0x68532410, s56
s_cselect_b32 s57, 0x97, s57
s_cmp_eq_u32 s64, 2
s_cselect_b32 s56, 0x96435201, s56
s_cselect_b32 s57, 0x87, s57
s_cmp_eq_u32 s64, 3
s_cselect_b32 s56, 0x75463102, s56
s_cselect_b32 s57, 0x98, s57
s_lshl_b32 s27, s22, 2
s_lshr_b32 s32, 0x7520, s27
s_and_b32 s32, s32, 15
s_mul_i32 s27, s23, 1
s_add_u32 s32, s32, s27
s_waitcnt lgkmcnt(0)
s_mul_i32 s14, s14, 0x9E3779B1
s_add_u32 s14, s14, 0x85EBCA6B
v_mov_b32 v55, s14
v_mov_b32 v12, 162816
v_lshlrev_b32 v47, 7, v0
v_mov_b32 v25, 0
s_and_b32 s64, s56, 15
s_add_u32 s64, s64, s32
s_cmp_ge_u32 s64, 10
s_cselect_b32 s27, 10, 0
s_sub_u32 s64, s64, s27
s_mul_i32 s1, s15, 5
s_lshr_b32 s1, s1, 2
v_and_b32 v52, 31, v0
v_mul_u32_u24 v53, 10, v52
v_lshrrev_b32 v21, 5, v0
v_add3_u32 v53, v53, v21, s1
v_lshlrev_b32 v53, 7, v53
s_mov_b32 s1, 262144
s_lshl_b32 s0, s21, 7
s_add_u32 s0, s0, s1
v_mul_u32_u24 v239, 3200, v21
v_lshl_add_u32 v239, v52, 2, v239
s_lshl_b32 s17, s16, 7
s_add_u32 s17, s17, 147456
v_add_u32 v239, s17, v239
v_and_b32 v23, 3, v0
v_or_b32 v238, 0x07060500, v23
v_lshlrev_b32 v250, 3, v23
v_lshrrev_b32 v250, v250, v55
s_lshl_b32 s55, s16, 10
s_add_u32 s17, s55, 155648
v_add_u32 v10, s17, v8
v_and_b32 v251, 15, v0
v_lshlrev_b32 v251, 3, v251
v_bfe_u32 v21, v0, 4, 1
v_lshl_add_u32 v251, v21, 9, v251
v_add_u32 v251, s17, v251
v_lshrrev_b32 v21, 4, v0
v_bfe_u32 v20, v0, 2, 2
v_lshl_add_u32 v22, v21, 3, v20
v_and_b32 v21, 1, v21
v_lshlrev_b32 v21, 5, v21
v_lshl_add_u32 v21, v23, 3, v21
v_lshl_add_u32 v236, v22, 6, v21
v_xor_b32 v237, 32, v236
v_lshl_add_u32 v22, v22, 8, v21
v_lshl_add_u32 v22, v20, 6, v22
s_lshl_b32 s17, s16, 6
v_xor_b32 v232, s17, v22
v_xor_b32 v233, 32, v232
v_xor_b32 v234, 128, v232
v_xor_b32 v235, 32, v234
v_mov_b32 v228, 0x3f803f80
v_mov_b32 v229, 0x3f803f80
v_mov_b32 v230, 0x3f803f80
v_mov_b32 v231, 0x3f803f80
s_mul_i32 s66, s29, 6400
s_add_u32 s66, s66, 393216
s_add_u32 s67, s66, 512
s_lshl_b32 s17, s16, 7
s_add_u32 s66, s66, s17
v_and_b32 v48, 0x300, v8
v_add_u32 v52, v48, v8
v_lshlrev_b32 v38, 3, v0
v_add_u32 v252, 160768, v38
v_add_u32 v253, 161792, v7
v_add_u32 v9, v12, v7
v_bfe_u32 v17, v0, 3, 2
v_cmp_eq_u32 vcc, 1, v17

s_barrier
v_add_u32 v20, 114688, v8
s_and_b32 s17, s16, 1
s_lshl_b32 s18, s17, 13
v_add_u32 v21, s18, v20
s_lshl_b32 s18, s17, 11
v_add_u32 v22, s18, v20
ds_read_b128 v[108:111], v20 offset:0
ds_read_b128 v[124:127], v20 offset:1024
ds_read_b128 v[112:115], v20 offset:2048
ds_read_b128 v[128:131], v20 offset:3072
ds_read_b128 v[116:119], v20 offset:4096
ds_read_b128 v[132:135], v20 offset:5120
ds_read_b128 v[120:123], v20 offset:6144
ds_read_b128 v[136:139], v20 offset:7168
ds_read_b128 v[76:79], v21 offset:8192
ds_read_b128 v[92:95], v21 offset:12288
ds_read_b128 v[80:83], v21 offset:9216
ds_read_b128 v[96:99], v21 offset:13312
ds_read_b128 v[84:87], v21 offset:10240
ds_read_b128 v[100:103], v21 offset:14336
ds_read_b128 v[88:91], v21 offset:11264
ds_read_b128 v[104:107], v21 offset:15360
ds_read_b128 v[64:67], v22 offset:24576
ds_read_b128 v[68:71], v22 offset:25600
s_waitcnt lgkmcnt(0)
v_mov_b32 v17, 0
v_mov_b32 v19, 0
v_mov_b32 v21, 0
v_mov_b32 v23, 0
s_waitcnt vmcnt(5)
v_cndmask_b32 v13, 0, v13, vcc
v_cndmask_b32 v14, 0, v14, vcc
v_cndmask_b32 v15, 0, v15, vcc
v_and_b32 v16, 0xffff, v13
v_lshrrev_b32 v18, 16, v13
v_and_b32 v20, 0xffff, v14
v_lshrrev_b32 v22, 16, v14
ds_write_b128 v10, v[16:19]
ds_write_b128 v10, v[20:23] offset:2048
s_cmp_eq_u32 s16, 0
s_cbranch_scc0 L_hp_n0
v_and_b32 v16, 0xffff, v15
v_lshrrev_b32 v18, 16, v15
ds_write_b128 v10, v[16:19] offset:4096
L_hp_n0:

s_waitcnt lgkmcnt(0)
v_cmp_gt_u32 vcc, 16, v0
s_cmp_eq_u32 s34, 1
s_cbranch_scc1 L_hp_D
s_cmp_eq_u32 s33, 0
s_cbranch_scc1 L_hp_4
s_barrier
s_add_u32 m0, s50, 0
s_nop 0
buffer_load_dwordx4 v5, s[76:79], s48 offen lds
s_add_u32 m0, s50, 1024
s_add_u32 s48, s48, 10240
buffer_load_dwordx4 v5, s[76:79], s48 offen lds
s_add_u32 m0, s50, 2048
s_add_u32 s48, s48, 10240
buffer_load_dwordx4 v5, s[76:79], s48 offen lds
s_add_u32 m0, s50, 3072
s_add_u32 s48, s48, 10240
buffer_load_dwordx4 v5, s[76:79], s48 offen lds
s_cmp_eq_u32 s16, 0
s_cbranch_scc0 L_on5
ds_read_b32 v24, v9 offset:256
s_lshl_b32 s17, s26, 4
s_add_u32 s17, s17, s29
s_lshl_b32 s17, s17, 7
s_add_u32 s17, s17, 65536
s_mov_b32 exec_hi, 0
s_waitcnt lgkmcnt(0)
buffer_store_dword v24, v7, s[44:47], s17 offen sc1
s_mov_b64 exec, -1
L_on5:
ds_read_b64_tr_b16 v[16:17], v232 offset:16384
ds_read_b64_tr_b16 v[18:19], v232 offset:17408
ds_read_b64_tr_b16 v[20:21], v232 offset:24576
ds_read_b64_tr_b16 v[22:23], v232 offset:25600
ds_read_b64_tr_b16 v[24:25], v233 offset:16384
ds_read_b64_tr_b16 v[26:27], v233 offset:17408
ds_read_b64_tr_b16 v[28:29], v233 offset:24576
ds_read_b64_tr_b16 v[30:31], v233 offset:25600
ds_read_b64_tr_b16 v[32:33], v234 offset:16384
ds_read_b64_tr_b16 v[34:35], v234 offset:17408
ds_read_b64_tr_b16 v[36:37], v234 offset:24576
ds_read_b64_tr_b16 v[38:39], v234 offset:25600
ds_read_b64_tr_b16 v[40:41], v235 offset:16384
ds_read_b64_tr_b16 v[42:43], v235 offset:17408
ds_read_b64_tr_b16 v[44:45], v235 offset:24576
ds_read_b64_tr_b16 v[46:47], v235 offset:25600
s_mul_i32 s18, s64, 640
s_add_u32 s17, s66, s18
s_waitcnt lgkmcnt(0)
v_mfma_f32_16x16x32_bf16 v[212:215], v[228:231], v[16:19], 0
v_mfma_f32_16x16x32_bf16 v[216:219], v[228:231], v[24:27], 0
v_mfma_f32_16x16x32_bf16 v[220:223], v[228:231], v[32:35], 0
v_mfma_f32_16x16x32_bf16 v[224:227], v[228:231], v[40:43], 0
v_mfma_f32_16x16x32_bf16 v[212:215], v[228:231], v[20:23], v[212:215]
v_mfma_f32_16x16x32_bf16 v[216:219], v[228:231], v[28:31], v[216:219]
v_mfma_f32_16x16x32_bf16 v[220:223], v[228:231], v[36:39], v[220:223]
v_mfma_f32_16x16x32_bf16 v[224:227], v[228:231], v[44:47], v[224:227]
s_nop 7
v_cndmask_b32 v212, v216, v212, vcc
v_cndmask_b32 v220, v224, v220, vcc
v_perm_b32 v212, v212, v55, v238
v_perm_b32 v220, v220, v55, v238
s_mov_b32 exec_hi, 0
buffer_store_dword v212, v7, s[44:47], s17 offen sc1
buffer_store_dword v220, v7, s[44:47], s17 offen offset:256 sc1
s_mov_b64 exec, -1
s_barrier
s_cmp_eq_u32 s16, 1
s_cbranch_scc0 L_on6
ds_read_b64_tr_b16 v[16:17], v236 offset:32768
ds_read_b64_tr_b16 v[18:19], v236 offset:33024
ds_read_b64_tr_b16 v[20:21], v236 offset:34816
ds_read_b64_tr_b16 v[22:23], v236 offset:35072
ds_read_b64_tr_b16 v[24:25], v237 offset:32768
ds_read_b64_tr_b16 v[26:27], v237 offset:33024
ds_read_b64_tr_b16 v[28:29], v237 offset:34816
ds_read_b64_tr_b16 v[30:31], v237 offset:35072
s_mul_i32 s18, s64, 640
s_add_u32 s17, s67, s18
s_waitcnt lgkmcnt(0)
v_mfma_f32_16x16x32_bf16 v[212:215], v[228:231], v[16:19], 0
v_mfma_f32_16x16x32_bf16 v[216:219], v[228:231], v[24:27], 0
v_mfma_f32_16x16x32_bf16 v[212:215], v[228:231], v[20:23], v[212:215]
v_mfma_f32_16x16x32_bf16 v[216:219], v[228:231], v[28:31], v[216:219]
s_nop 7
v_cndmask_b32 v212, v216, v212, vcc
v_perm_b32 v212, v212, v55, v238
s_mov_b32 exec_hi, 0
buffer_store_dword v212, v7, s[44:47], s17 offen sc1
s_mov_b64 exec, -1
L_on6:
s_barrier
s_waitcnt vmcnt(0)
v_lshrrev_b32 v30, 2, v0
v_lshlrev_b32 v30, 7, v30
v_and_b32 v31, 3, v0
v_lshl_add_u32 v30, v31, 3, v30
v_add_u32 v30, s50, v30
v_lshlrev_b32 v31, 4, v0
ds_read_b64_tr_b16 v[32:33], v30 offset:0
ds_read_b64_tr_b16 v[34:35], v30 offset:2048
ds_read_b64_tr_b16 v[36:37], v30 offset:32
ds_read_b64_tr_b16 v[38:39], v30 offset:2080
ds_read_b64_tr_b16 v[40:41], v30 offset:64
ds_read_b64_tr_b16 v[42:43], v30 offset:2112
ds_read_b64_tr_b16 v[44:45], v30 offset:96
ds_read_b64_tr_b16 v[46:47], v30 offset:2144
s_waitcnt lgkmcnt(6)
buffer_store_dwordx4 v[32:35], v31, s[44:47], s51 offen offset:0 sc1
s_waitcnt lgkmcnt(4)
buffer_store_dwordx4 v[36:39], v31, s[44:47], s51 offen offset:1024 sc1
s_waitcnt lgkmcnt(2)
buffer_store_dwordx4 v[40:43], v31, s[44:47], s51 offen offset:2048 sc1
s_waitcnt lgkmcnt(0)
buffer_store_dwordx4 v[44:47], v31, s[44:47], s51 offen offset:3072 sc1
s_barrier
s_waitcnt vmcnt(0)
s_barrier
s_cmp_eq_u32 s16, 0
s_cbranch_scc0 L_on7
s_mov_b32 exec_hi, 0
buffer_store_dword v55, v7, s[44:47], s0 offen sc1
s_mov_b64 exec, -1
L_on7:
s_cmp_eq_u32 s16, 1
s_cbranch_scc0 L_on8
s_lshl_b32 s17, s26, 11
s_add_u32 s17, s17, 65536
buffer_load_dwordx4 v[56:59], v8, s[44:47], s17 offen sc1
buffer_load_dwordx4 v[60:63], v8, s[44:47], s17 offen offset:1024 sc1
s_lshl_b32 s17, s20, 11
s_lshl_b32 s18, s31, 8
s_add_u32 s17, s17, s18
s_add_u32 s17, s17, 65536
buffer_load_dwordx4 v[48:51], v52, s[44:47], s17 offen sc1
L_on8:
s_cmp_eq_u32 s16, 0
s_cbranch_scc0 L_on9
s_mul_i32 s17, s29, 6400
s_add_u32 s17, s17, 393216
s_mov_b32 m0, 147456
s_add_u32 s18, s17, 4096
buffer_load_dwordx4 v8, s[44:47], s17 offen offset:0 sc1 lds
buffer_load_dwordx4 v8, s[44:47], s17 offen offset:1024 sc1 lds
buffer_load_dwordx4 v8, s[44:47], s17 offen offset:2048 sc1 lds
buffer_load_dwordx4 v8, s[44:47], s17 offen offset:3072 sc1 lds
s_mov_b32 m0, 151552
s_nop 0
buffer_load_dwordx4 v8, s[44:47], s18 offen offset:0 sc1 lds
buffer_load_dwordx4 v8, s[44:47], s18 offen offset:1024 sc1 lds
buffer_load_dwordx4 v8, s[44:47], s18 offen offset:2048 sc1 lds
L_on9:
s_barrier
s_waitcnt vmcnt(0)
s_barrier
ds_read_b32 v16, v239 offset:0
ds_read_b32 v17, v239 offset:640
ds_read_b32 v18, v239 offset:1280
ds_read_b32 v19, v239 offset:1920
ds_read_b32 v20, v239 offset:2560
ds_read_b32 v21, v239 offset:256
ds_read_b32 v22, v239 offset:896
ds_read_b32 v23, v239 offset:1536
ds_read_b32 v24, v239 offset:2176
ds_read_b32 v25, v239 offset:2816
ds_read_b32 v26, v239 offset:512
ds_read_b32 v27, v239 offset:1152
ds_read_b32 v28, v239 offset:1792
ds_read_b32 v29, v239 offset:2432
ds_read_b32 v30, v239 offset:3072
s_cmp_eq_u32 s16, 1
s_cbranch_scc0 L_on10
s_mov_b32 s19, 0
s_mov_b32 s17, 0x01000100
L_l_sc5:
v_cmp_ne_u32 vcc, v55, v59
v_cmp_ne_u32 s[68:69], v55, v63
v_cmp_ne_u32 s[70:71], v55, v51
s_add_u32 s19, s19, 1
s_cmp_gt_u32 s19, 200000
s_cbranch_scc1 L_l_scd5
s_or_b64 vcc, vcc, s[68:69]
s_or_b64 vcc, vcc, s[70:71]
s_cbranch_vccz L_l_scd5
s_sleep 4
s_lshl_b32 s17, s26, 11
s_add_u32 s17, s17, 65536
buffer_load_dwordx4 v[56:59], v8, s[44:47], s17 offen sc1
buffer_load_dwordx4 v[60:63], v8, s[44:47], s17 offen offset:1024 sc1
s_lshl_b32 s17, s20, 11
s_lshl_b32 s18, s31, 8
s_add_u32 s17, s17, s18
s_add_u32 s17, s17, 65536
buffer_load_dwordx4 v[48:51], v52, s[44:47], s17 offen sc1
s_mov_b32 s17, 0x01000100
s_waitcnt vmcnt(0)
s_branch L_l_sc5
L_l_scd5:
v_perm_b32 v40, v56, v56, s17
v_lshrrev_b32 v41, 16, v56
v_perm_b32 v42, v60, v60, s17
v_lshrrev_b32 v43, 16, v60
ds_write_b32 v253, v57
ds_write_b32 v253, v61 offset:256
ds_write_b32 v253, v58 offset:512
ds_write_b32 v253, v62 offset:768
ds_write_b32 v253, v49 offset:1536
ds_write_b64 v252, v[40:41]
ds_write_b64 v252, v[42:43] offset:512
L_on10:
s_cmp_eq_u32 s16, 0
s_cbranch_scc0 L_on11
s_mov_b32 s19, 0
L_ck12:
s_waitcnt lgkmcnt(0)
v_xor_b32 v38, v250, v26
v_xor_b32 v39, v250, v27
v_xor_b32 v40, v250, v28
v_xor_b32 v41, v250, v29
v_xor_b32 v42, v250, v30
v_or3_b32 v38, v38, v39, v40
v_add_f32 v39, v26, v27
v_or3_b32 v38, v38, v41, v42
v_add_f32 v40, v28, v29
v_and_b32 v38, 0xff, v38
v_add_f32 v39, v39, v30
v_cmp_ne_u32 vcc, 0, v38
v_add_f32 v39, v39, v40
s_add_u32 s19, s19, 1
s_cmp_gt_u32 s19, 200000
s_cbranch_scc1 L_ck12d
s_cbranch_vccz L_ck12d
s_sleep 4
s_mul_i32 s17, s29, 6400
s_add_u32 s17, s17, 393216
s_mov_b32 m0, 147456
s_add_u32 s18, s17, 4096
buffer_load_dwordx4 v8, s[44:47], s17 offen offset:0 sc1 lds
buffer_load_dwordx4 v8, s[44:47], s17 offen offset:1024 sc1 lds
buffer_load_dwordx4 v8, s[44:47], s17 offen offset:2048 sc1 lds
buffer_load_dwordx4 v8, s[44:47], s17 offen offset:3072 sc1 lds
s_mov_b32 m0, 151552
s_nop 0
buffer_load_dwordx4 v8, s[44:47], s18 offen offset:0 sc1 lds
buffer_load_dwordx4 v8, s[44:47], s18 offen offset:1024 sc1 lds
buffer_load_dwordx4 v8, s[44:47], s18 offen offset:2048 sc1 lds
s_waitcnt vmcnt(0)
ds_read_b32 v26, v239 offset:512
ds_read_b32 v27, v239 offset:1152
ds_read_b32 v28, v239 offset:1792
ds_read_b32 v29, v239 offset:2432
ds_read_b32 v30, v239 offset:3072
s_branch L_ck12
L_ck12d:
v_mov_b32 v40, v39
s_nop 1
v_permlane32_swap_b32 v39, v40
s_nop 1
v_add_f32 v39, v39, v40
v_cvt_pk_bf16_f32 v40, v39, v39
v_lshlrev_b32 v40, 16, v40
v_sub_f32 v39, v39, v40
v_cvt_pk_bf16_f32 v39, v40, v39
s_mov_b32 exec_hi, 0
ds_write_b32 v251, v39 offset:4096
s_mov_b64 exec, -1
L_on11:
s_barrier
s_cmp_eq_u32 s16, 0
s_cbranch_scc0 L_on13
s_mov_b32 exec_lo, 0x1ffffff
s_mov_b32 exec_hi, 0x1ffffff
buffer_load_dword v54, v53, s[44:47], s1 offen sc1
s_mov_b64 exec, -1
L_on13:
s_mov_b32 s19, 0
L_ck14:
s_waitcnt lgkmcnt(0)
v_xor_b32 v38, v250, v16
v_xor_b32 v39, v250, v17
v_xor_b32 v40, v250, v18
v_xor_b32 v41, v250, v19
v_xor_b32 v42, v250, v20
v_or3_b32 v38, v38, v39, v40
v_add_f32 v39, v16, v17
v_or3_b32 v38, v38, v41, v42
v_add_f32 v40, v18, v19
v_and_b32 v38, 0xff, v38
v_add_f32 v39, v39, v20
v_cmp_ne_u32 vcc, 0, v38
v_add_f32 v39, v39, v40
s_add_u32 s19, s19, 1
s_cmp_gt_u32 s19, 200000
s_cbranch_scc1 L_ck14d
s_cbranch_vccz L_ck14d
s_sleep 4
s_mul_i32 s17, s29, 6400
s_add_u32 s17, s17, 393216
s_mov_b32 m0, 147456
s_add_u32 s18, s17, 4096
buffer_load_dwordx4 v8, s[44:47], s17 offen offset:0 sc1 lds
buffer_load_dwordx4 v8, s[44:47], s17 offen offset:1024 sc1 lds
buffer_load_dwordx4 v8, s[44:47], s17 offen offset:2048 sc1 lds
buffer_load_dwordx4 v8, s[44:47], s17 offen offset:3072 sc1 lds
s_mov_b32 m0, 151552
s_nop 0
buffer_load_dwordx4 v8, s[44:47], s18 offen offset:0 sc1 lds
buffer_load_dwordx4 v8, s[44:47], s18 offen offset:1024 sc1 lds
buffer_load_dwordx4 v8, s[44:47], s18 offen offset:2048 sc1 lds
s_waitcnt vmcnt(0)
ds_read_b32 v16, v239 offset:0
ds_read_b32 v17, v239 offset:640
ds_read_b32 v18, v239 offset:1280
ds_read_b32 v19, v239 offset:1920
ds_read_b32 v20, v239 offset:2560
s_branch L_ck14
L_ck14d:
v_mov_b32 v40, v39
s_nop 1
v_permlane32_swap_b32 v39, v40
s_nop 1
v_add_f32 v39, v39, v40
v_cvt_pk_bf16_f32 v40, v39, v39
v_lshlrev_b32 v40, 16, v40
v_sub_f32 v39, v39, v40
v_cvt_pk_bf16_f32 v39, v40, v39
s_mov_b32 exec_hi, 0
ds_write_b32 v251, v39 offset:0
s_mov_b64 exec, -1
s_barrier
s_mov_b32 s19, 0
L_ck15:
s_waitcnt lgkmcnt(0)
v_xor_b32 v38, v250, v21
v_xor_b32 v39, v250, v22
v_xor_b32 v40, v250, v23
v_xor_b32 v41, v250, v24
v_xor_b32 v42, v250, v25
v_or3_b32 v38, v38, v39, v40
v_add_f32 v39, v21, v22
v_or3_b32 v38, v38, v41, v42
v_add_f32 v40, v23, v24
v_and_b32 v38, 0xff, v38
v_add_f32 v39, v39, v25
v_cmp_ne_u32 vcc, 0, v38
v_add_f32 v39, v39, v40
s_add_u32 s19, s19, 1
s_cmp_gt_u32 s19, 200000
s_cbranch_scc1 L_ck15d
s_cbranch_vccz L_ck15d
s_sleep 4
s_mul_i32 s17, s29, 6400
s_add_u32 s17, s17, 393216
s_mov_b32 m0, 147456
s_add_u32 s18, s17, 4096
buffer_load_dwordx4 v8, s[44:47], s17 offen offset:0 sc1 lds
buffer_load_dwordx4 v8, s[44:47], s17 offen offset:1024 sc1 lds
buffer_load_dwordx4 v8, s[44:47], s17 offen offset:2048 sc1 lds
buffer_load_dwordx4 v8, s[44:47], s17 offen offset:3072 sc1 lds
s_mov_b32 m0, 151552
s_nop 0
buffer_load_dwordx4 v8, s[44:47], s18 offen offset:0 sc1 lds
buffer_load_dwordx4 v8, s[44:47], s18 offen offset:1024 sc1 lds
buffer_load_dwordx4 v8, s[44:47], s18 offen offset:2048 sc1 lds
s_waitcnt vmcnt(0)
ds_read_b32 v21, v239 offset:256
ds_read_b32 v22, v239 offset:896
ds_read_b32 v23, v239 offset:1536
ds_read_b32 v24, v239 offset:2176
ds_read_b32 v25, v239 offset:2816
s_branch L_ck15
L_ck15d:
v_mov_b32 v40, v39
s_nop 1
v_permlane32_swap_b32 v39, v40
s_nop 1
v_add_f32 v39, v39, v40
v_cvt_pk_bf16_f32 v40, v39, v39
v_lshlrev_b32 v40, 16, v40
v_sub_f32 v39, v39, v40
v_cvt_pk_bf16_f32 v39, v40, v39
s_mov_b32 exec_hi, 0
ds_write_b32 v251, v39 offset:2048
s_mov_b64 exec, -1
s_waitcnt vmcnt(0)
s_cmp_eq_u32 s16, 0
s_cbranch_scc0 L_on16
s_mov_b32 s19, 0
s_branch L_po17c
L_po17:
s_mov_b32 exec_lo, 0x1ffffff
s_mov_b32 exec_hi, 0x1ffffff
buffer_load_dword v54, v53, s[44:47], s1 offen sc1
s_waitcnt vmcnt(0)
L_po17c:
s_mov_b32 exec_lo, 0x1ffffff
s_mov_b32 exec_hi, 0x1ffffff
v_cmp_ne_u32 vcc, v55, v54
s_mov_b64 exec, -1
s_add_u32 s19, s19, 1
s_cmp_gt_u32 s19, 200000
s_cbranch_scc1 L_po17d
s_cbranch_vccz L_po17d
s_sleep 4
s_branch L_po17
L_po17d:
L_on16:
s_waitcnt lgkmcnt(0)
s_barrier
s_lshl_b32 s17, s31, 10
s_lshl_b32 s18, s20, 2
s_add_u32 s17, s17, s18
s_mul_i32 s17, s17, 1280
s_mul_i32 s18, s15, 160
s_add_u32 s17, s17, s18
buffer_load_dwordx4 v[172:175], v240, s[36:39], s17 offen
buffer_load_dwordx4 v[180:183], v241, s[36:39], s17 offen
buffer_load_dwordx4 v[188:191], v242, s[36:39], s17 offen
buffer_load_dwordx4 v[196:199], v243, s[36:39], s17 offen
buffer_load_dwordx4 v[204:207], v244, s[36:39], s17 offen
L_hp_gap:
s_setprio 0
s_mov_b32 s17, 0x80000000
s_mov_b32 s18, 0x80008000
v_xor_b32 v140, s17, v108
v_xor_b32 v141, s17, v109
v_xor_b32 v142, s17, v110
v_xor_b32 v143, s17, v111
v_xor_b32 v144, s17, v112
v_xor_b32 v145, s17, v113
v_xor_b32 v146, s17, v114
v_xor_b32 v147, s17, v115
v_xor_b32 v148, s17, v116
v_xor_b32 v149, s17, v117
v_xor_b32 v150, s17, v118
v_xor_b32 v151, s17, v119
v_xor_b32 v152, s17, v120
v_xor_b32 v153, s17, v121
v_xor_b32 v154, s17, v122
v_xor_b32 v155, s17, v123
v_xor_b32 v156, s17, v124
v_xor_b32 v157, s17, v125
v_xor_b32 v158, s17, v126
v_xor_b32 v159, s17, v127
v_xor_b32 v160, s17, v128
v_xor_b32 v161, s17, v129
v_xor_b32 v162, s17, v130
v_xor_b32 v163, s17, v131
v_xor_b32 v164, s17, v132
v_xor_b32 v165, s17, v133
v_xor_b32 v166, s17, v134
v_xor_b32 v167, s17, v135
v_xor_b32 v168, s17, v136
v_xor_b32 v169, s17, v137
v_xor_b32 v170, s17, v138
v_xor_b32 v171, s17, v139
v_xor_b32 v72, s18, v68
v_xor_b32 v73, s18, v69
v_xor_b32 v74, s18, v70
v_xor_b32 v75, s18, v71
s_mov_b32 s19, 0
L_sp18:
ds_read_b32 v16, v12 offset:8
s_waitcnt lgkmcnt(0)
v_readfirstlane_b32 s27, v16
s_add_u32 s19, s19, 1
s_cmp_gt_u32 s19, 200000
s_cbranch_scc1 L_sp18d
s_cmp_ge_u32 s27, 4
s_cbranch_scc1 L_sp18d
s_sleep 1
s_branch L_sp18
L_sp18d:
s_setprio 3
s_waitcnt vmcnt(0)
v_lshlrev_b32 v32, 16, v172
v_and_b32 v33, 0xffff0000, v172
v_lshlrev_b32 v40, 16, v176
v_and_b32 v41, 0xffff0000, v176
v_add_f32 v32, v32, v40
v_add_f32 v33, v33, v41
v_lshlrev_b32 v34, 16, v173
v_and_b32 v35, 0xffff0000, v173
v_lshlrev_b32 v40, 16, v177
v_and_b32 v41, 0xffff0000, v177
v_add_f32 v34, v34, v40
v_add_f32 v35, v35, v41
v_lshlrev_b32 v36, 16, v174
v_and_b32 v37, 0xffff0000, v174
v_lshlrev_b32 v40, 16, v178
v_and_b32 v41, 0xffff0000, v178
v_add_f32 v36, v36, v40
v_add_f32 v37, v37, v41
v_lshlrev_b32 v38, 16, v175
v_and_b32 v39, 0xffff0000, v175
v_lshlrev_b32 v40, 16, v179
v_and_b32 v41, 0xffff0000, v179
v_add_f32 v38, v38, v40
v_add_f32 v39, v39, v41
v_xor_b32 v40, 16, v245
ds_write_b128 v245, v[32:35]
ds_write_b128 v40, v[36:39]
v_lshlrev_b32 v32, 16, v180
v_and_b32 v33, 0xffff0000, v180
v_lshlrev_b32 v40, 16, v184
v_and_b32 v41, 0xffff0000, v184
v_add_f32 v32, v32, v40
v_add_f32 v33, v33, v41
v_lshlrev_b32 v34, 16, v181
v_and_b32 v35, 0xffff0000, v181
v_lshlrev_b32 v40, 16, v185
v_and_b32 v41, 0xffff0000, v185
v_add_f32 v34, v34, v40
v_add_f32 v35, v35, v41
v_lshlrev_b32 v36, 16, v182
v_and_b32 v37, 0xffff0000, v182
v_lshlrev_b32 v40, 16, v186
v_and_b32 v41, 0xffff0000, v186
v_add_f32 v36, v36, v40
v_add_f32 v37, v37, v41
v_lshlrev_b32 v38, 16, v183
v_and_b32 v39, 0xffff0000, v183
v_lshlrev_b32 v40, 16, v187
v_and_b32 v41, 0xffff0000, v187
v_add_f32 v38, v38, v40
v_add_f32 v39, v39, v41
v_xor_b32 v40, 16, v246
ds_write_b128 v246, v[32:35]
ds_write_b128 v40, v[36:39]
v_lshlrev_b32 v32, 16, v188
v_and_b32 v33, 0xffff0000, v188
v_lshlrev_b32 v40, 16, v192
v_and_b32 v41, 0xffff0000, v192
v_add_f32 v32, v32, v40
v_add_f32 v33, v33, v41
v_lshlrev_b32 v34, 16, v189
v_and_b32 v35, 0xffff0000, v189
v_lshlrev_b32 v40, 16, v193
v_and_b32 v41, 0xffff0000, v193
v_add_f32 v34, v34, v40
v_add_f32 v35, v35, v41
v_lshlrev_b32 v36, 16, v190
v_and_b32 v37, 0xffff0000, v190
v_lshlrev_b32 v40, 16, v194
v_and_b32 v41, 0xffff0000, v194
v_add_f32 v36, v36, v40
v_add_f32 v37, v37, v41
v_lshlrev_b32 v38, 16, v191
v_and_b32 v39, 0xffff0000, v191
v_lshlrev_b32 v40, 16, v195
v_and_b32 v41, 0xffff0000, v195
v_add_f32 v38, v38, v40
v_add_f32 v39, v39, v41
v_xor_b32 v40, 16, v247
ds_write_b128 v247, v[32:35]
ds_write_b128 v40, v[36:39]
v_lshlrev_b32 v32, 16, v196
v_and_b32 v33, 0xffff0000, v196
v_lshlrev_b32 v40, 16, v200
v_and_b32 v41, 0xffff0000, v200
v_add_f32 v32, v32, v40
v_add_f32 v33, v33, v41
v_lshlrev_b32 v34, 16, v197
v_and_b32 v35, 0xffff0000, v197
v_lshlrev_b32 v40, 16, v201
v_and_b32 v41, 0xffff0000, v201
v_add_f32 v34, v34, v40
v_add_f32 v35, v35, v41
v_lshlrev_b32 v36, 16, v198
v_and_b32 v37, 0xffff0000, v198
v_lshlrev_b32 v40, 16, v202
v_and_b32 v41, 0xffff0000, v202
v_add_f32 v36, v36, v40
v_add_f32 v37, v37, v41
v_lshlrev_b32 v38, 16, v199
v_and_b32 v39, 0xffff0000, v199
v_lshlrev_b32 v40, 16, v203
v_and_b32 v41, 0xffff0000, v203
v_add_f32 v38, v38, v40
v_add_f32 v39, v39, v41
v_xor_b32 v40, 16, v248
ds_write_b128 v248, v[32:35]
ds_write_b128 v40, v[36:39]
v_lshlrev_b32 v32, 16, v204
v_and_b32 v33, 0xffff0000, v204
v_lshlrev_b32 v40, 16, v208
v_and_b32 v41, 0xffff0000, v208
v_add_f32 v32, v32, v40
v_add_f32 v33, v33, v41
v_lshlrev_b32 v34, 16, v205
v_and_b32 v35, 0xffff0000, v205
v_lshlrev_b32 v40, 16, v209
v_and_b32 v41, 0xffff0000, v209
v_add_f32 v34, v34, v40
v_add_f32 v35, v35, v41
v_lshlrev_b32 v36, 16, v206
v_and_b32 v37, 0xffff0000, v206
v_lshlrev_b32 v40, 16, v210
v_and_b32 v41, 0xffff0000, v210
v_add_f32 v36, v36, v40
v_add_f32 v37, v37, v41
v_lshlrev_b32 v38, 16, v207
v_and_b32 v39, 0xffff0000, v207
v_lshlrev_b32 v40, 16, v211
v_and_b32 v41, 0xffff0000, v211
v_add_f32 v38, v38, v40
v_add_f32 v39, v39, v41
v_xor_b32 v40, 16, v249
ds_write_b128 v249, v[32:35]
ds_write_b128 v40, v[36:39]
s_waitcnt lgkmcnt(0)
v_mov_b32 v16, 1
s_mov_b64 exec, 1
ds_add_u32 v12, v16 offset:16
s_mov_b64 exec, -1
s_cmp_eq_u32 s34, 1
s_cbranch_scc0 L_l_fft
s_mov_b32 s19, 0
L_sp19:
ds_read_b32 v16, v12 offset:64
s_waitcnt lgkmcnt(0)
v_readfirstlane_b32 s27, v16
s_add_u32 s19, s19, 1
s_cmp_gt_u32 s19, 200000
s_cbranch_scc1 L_sp19d
s_cmp_ge_u32 s27, 1
s_cbranch_scc1 L_sp19d
s_sleep 1
s_branch L_sp19
L_sp19d:
s_xor_b32 s9, s16, 2
s_lshl_b32 s18, s9, 3
s_lshr_b32 s17, 0x2f282018, s18
s_and_b32 s17, s17, 0xff
s_add_u32 s17, s17, 1
s_mul_i32 s8, s17, 40960
s_mul_i32 s17, s15, 5120
s_add_u32 s8, s8, s17
s_add_u32 s8, s8, 1048576
s_mul_i32 s7, s9, 35840
s_cmp_ge_u32 s9, 2
s_cselect_b32 s27, 2048, 0
s_add_u32 s7, s7, s27
s_cmp_eq_u32 s9, 3
s_cselect_b32 s7, 104448, s7
s_lshl_b32 s17, s24, 1
s_add_u32 s17, s17, s31
s_cmp_ge_u32 s17, 6
s_cselect_b32 s18, 6, 0
s_sub_u32 s17, s17, s18
s_sub_u32 s6, 6, s17
s_mul_i32 s4, s17, 5120
s_add_u32 s4, s4, s7
s_mul_i32 s5, s17, 40960
s_add_u32 s5, s5, s8
s_mov_b32 s18, 6
L_l_dmaa2:
s_mov_b32 m0, s4
s_add_u32 s17, s5, 4096
buffer_load_dwordx4 v8, s[44:47], s5 offen offset:0 sc1 lds
buffer_load_dwordx4 v8, s[44:47], s5 offen offset:1024 sc1 lds
buffer_load_dwordx4 v8, s[44:47], s5 offen offset:2048 sc1 lds
buffer_load_dwordx4 v8, s[44:47], s5 offen offset:3072 sc1 lds
s_add_u32 m0, s4, 4096
s_add_u32 s4, s4, 5120
buffer_load_dwordx4 v8, s[44:47], s17 offen sc1 lds
s_add_u32 s5, s5, 40960
s_sub_u32 s6, s6, 1
s_cmp_eq_u32 s6, 0
s_cselect_b32 s4, s7, s4
s_cselect_b32 s5, s8, s5
s_sub_u32 s18, s18, 1
s_cmp_lg_u32 s18, 0
s_cbranch_scc1 L_l_dmaa2
L_l_fft:
s_mov_b32 s17, s21
s_lshr_b32 s18, s17, 2
s_lshl_b32 s18, s18, 2
s_and_b32 s5, s17, 1
s_lshl_b32 s5, s5, 1
s_add_u32 s18, s18, s5
s_add_u32 s18, s18, s23
s_add_u32 s17, s18, 256
s_cmp_eq_u32 s2, 24
s_movk_i32 s18, 320
s_cselect_b32 s18, s18, -1
s_cmp_eq_u32 s34, 1
s_cselect_b32 s17, s17, s18
s_cmp_lt_u32 s16, 2
s_cselect_b32 s4, s2, s17
s_cmp_eq_u32 s16, 1
s_cbranch_scc0 L_l_nhp
s_cmp_eq_u32 s34, 1
s_cbranch_scc0 L_gt20w
s_mov_b32 s19, 0
L_sp21:
ds_read_b32 v16, v12 offset:64
s_waitcnt lgkmcnt(0)
v_readfirstlane_b32 s27, v16
s_add_u32 s19, s19, 1
s_cmp_gt_u32 s19, 200000
s_cbranch_scc1 L_sp21d
s_cmp_ge_u32 s27, 1
s_cbranch_scc1 L_sp21d
s_sleep 1
s_branch L_sp21
L_sp21d:
s_sleep 0
s_branch L_gt20e
L_gt20w:
s_mov_b32 s19, 0
L_sp22:
ds_read_b32 v16, v12 offset:68
s_waitcnt lgkmcnt(0)
v_readfirstlane_b32 s27, v16
s_add_u32 s19, s19, 1
s_cmp_gt_u32 s19, 200000
s_cbranch_scc1 L_sp22d
s_cmp_ge_u32 s27, 4
s_cbranch_scc1 L_sp22d
s_sleep 1
s_branch L_sp22
L_sp22d:
L_gt20e:
v_lshlrev_b32 v14, 7, v0
s_lshl_b32 s17, s20, 11
s_add_u32 s17, s17, 294912
s_mov_b32 s19, 0
L_po23:
s_mov_b64 exec, 0x3838
buffer_load_dword v16, v14, s[44:47], s17 offen sc1
s_waitcnt vmcnt(0)
L_po23c:
s_mov_b64 exec, 0x3838
v_cmp_ne_u32 vcc, v55, v16
s_mov_b64 exec, -1
s_add_u32 s19, s19, 1
s_cmp_gt_u32 s19, 200000
s_cbranch_scc1 L_po23d
s_cbranch_vccz L_po23d
s_sleep 8
s_branch L_po23
L_po23d:
v_mov_b32 v16, 1
ds_write_b32 v12, v16 offset:20
L_l_nhp:
s_cmp_gt_u32 s4, 320
s_cbranch_scc1 L_l_nofft
s_bitcmp1_b32 s4, 0
s_cselect_b32 s17, 128, 0
s_add_u32 s17, s17, 295680
v_and_b32 v14, 15, v0
v_lshlrev_b32 v14, 11, v14
v_bfe_u32 v15, v0, 4, 1
v_lshl_add_u32 v14, v15, 10, v14
v_mov_b32 v15, v12
s_cmp_eq_u32 s16, 0
s_cbranch_scc0 L_l_zspin
s_cmp_eq_u32 s34, 1
s_cbranch_scc0 L_gt24w
s_mov_b32 s19, 0
L_sp25:
ds_read_b32 v16, v12 offset:64
s_waitcnt lgkmcnt(0)
v_readfirstlane_b32 s27, v16
s_add_u32 s19, s19, 1
s_cmp_gt_u32 s19, 200000
s_cbranch_scc1 L_sp25d
s_cmp_ge_u32 s27, 1
s_cbranch_scc1 L_sp25d
s_sleep 1
s_branch L_sp25
L_sp25d:
s_sleep 0
s_branch L_gt24e
L_gt24w:
s_mov_b32 s19, 0
L_sp26:
ds_read_b32 v16, v12 offset:68
s_waitcnt lgkmcnt(0)
v_readfirstlane_b32 s27, v16
s_add_u32 s19, s19, 1
s_cmp_gt_u32 s19, 200000
s_cbranch_scc1 L_sp26d
s_cmp_ge_u32 s27, 4
s_cbranch_scc1 L_sp26d
s_sleep 1
s_branch L_sp26
L_sp26d:
s_cmp_eq_u32 s33, 1
s_cbranch_scc1 L_gt24e
s_mov_b32 s19, 0
L_sp27:
ds_read_b32 v16, v12 offset:20
s_waitcnt lgkmcnt(0)
v_readfirstlane_b32 s27, v16
s_add_u32 s19, s19, 1
s_cmp_gt_u32 s19, 200000
s_cbranch_scc1 L_sp27d
s_cmp_ge_u32 s27, 1
s_cbranch_scc1 L_sp27d
s_sleep 1
s_branch L_sp27
L_sp27d:
L_gt24e:
s_mov_b32 s19, 0
L_po28:
s_mov_b32 exec_hi, 0
buffer_load_dword v16, v14, s[44:47], s17 offen sc1
s_waitcnt vmcnt(0)
L_po28c:
s_mov_b32 exec_hi, 0
v_cmp_ne_u32 vcc, v55, v16
s_mov_b64 exec, -1
s_add_u32 s19, s19, 1
s_cmp_gt_u32 s19, 200000
s_cbranch_scc1 L_po28d
s_cbranch_vccz L_po28d
s_sleep 8
s_branch L_po28
L_po28d:
v_mov_b32 v16, 1
ds_write_b32 v12, v16 offset:48
s_branch L_l_zok
L_l_zspin:
s_mov_b32 s19, 0
L_sp29:
ds_read_b32 v16, v12 offset:48
s_waitcnt lgkmcnt(0)
v_readfirstlane_b32 s27, v16
s_add_u32 s19, s19, 1
s_cmp_gt_u32 s19, 200000
s_cbranch_scc1 L_sp29d
s_cmp_ge_u32 s27, 1
s_cbranch_scc1 L_sp29d
s_sleep 1
s_branch L_sp29
L_sp29d:
L_l_zok:
s_and_b32 s18, s16, 2
s_lshl_b32 s18, s18, 1
v_add_u32 v15, s18, v12
s_setprio 3
v_bfe_u32 v16, v0, 2, 2
v_lshlrev_b32 v16, 8, v16
v_lshrrev_b32 v17, 4, v0
v_lshl_add_u32 v16, v17, 6, v16
v_and_b32 v18, 3, v0
v_lshl_add_u32 v16, v18, 4, v16
s_lshl_b32 s5, s4, 12
s_add_u32 s5, s5, 11534336
s_add_u32 s6, s5, 1376256
s_cmp_eq_u32 s4, 320
s_cselect_b32 s6, 0x40000000, s6
buffer_load_dwordx4 v[172:175], v16, s[44:47], s5 offen offset:0 sc1
buffer_load_dwordx4 v[188:191], v16, s[44:47], s6 offen offset:0 sc1
buffer_load_dwordx4 v[176:179], v16, s[44:47], s5 offen offset:1024 sc1
buffer_load_dwordx4 v[192:195], v16, s[44:47], s6 offen offset:1024 sc1
buffer_load_dwordx4 v[180:183], v16, s[44:47], s5 offen offset:2048 sc1
buffer_load_dwordx4 v[196:199], v16, s[44:47], s6 offen offset:2048 sc1
buffer_load_dwordx4 v[184:187], v16, s[44:47], s5 offen offset:3072 sc1
buffer_load_dwordx4 v[200:203], v16, s[44:47], s6 offen offset:3072 sc1
s_lshl_b32 s9, s34, 2
s_or_b32 s9, s9, s16
s_cmp_eq_u32 s9, 7
s_cbranch_scc0 L_l_nzi
v_lshlrev_b32 v47, 7, v0
s_lshl_b32 s0, s20, 11
s_add_u32 s0, s0, 294912
s_mov_b64 exec, 0x0707
buffer_load_dword v56, v47, s[44:47], s0 offen sc1
s_mov_b64 exec, -1
L_l_nzi:
v_and_b32 v18, 15, v0
v_lshlrev_b32 v18, 4, v18
v_lshl_add_u32 v18, v17, 9, v18
s_lshl_b32 s5, s4, 13
s_and_b32 s17, s16, 1
s_lshl_b32 s18, s17, 11
s_add_u32 s5, s5, s18
s_add_u32 s5, s5, 14680064
s_add_u32 s6, s5, 4096

s_waitcnt vmcnt(6)
s_lshl_b32 s17, s34, 1
s_or_b32 s17, s17, s16
s_cmp_lt_u32 s17, 2
s_cbranch_scc1 L_l_nw2f
s_xor_b32 s17, s16, 2
s_lshl_b32 s17, s17, 2
v_add_u32 v16, s17, v12
ds_write_b32 v16, v12 offset:32
s_cmp_eq_u32 s34, 1
s_cbranch_scc1 L_l_nw2f
ds_write_b32 v16, v12 offset:40
L_l_nw2f:
s_waitcnt vmcnt(6)
v_mfma_f32_16x16x32_bf16 v[204:207], v[172:175], v[64:67], 0
v_mfma_f32_16x16x32_bf16 v[220:223], v[188:191], v[64:67], 0
v_mfma_f32_16x16x32_bf16 v[204:207], v[188:191], v[68:71], v[204:207]
v_mfma_f32_16x16x32_bf16 v[220:223], v[172:175], v[72:75], v[220:223]
s_waitcnt vmcnt(4)
v_mfma_f32_16x16x32_bf16 v[208:211], v[176:179], v[64:67], 0
v_mfma_f32_16x16x32_bf16 v[224:227], v[192:195], v[64:67], 0
v_mfma_f32_16x16x32_bf16 v[208:211], v[192:195], v[68:71], v[208:211]
v_mfma_f32_16x16x32_bf16 v[224:227], v[176:179], v[72:75], v[224:227]
s_waitcnt vmcnt(2)
v_mfma_f32_16x16x32_bf16 v[212:215], v[180:183], v[64:67], 0
v_mfma_f32_16x16x32_bf16 v[228:231], v[196:199], v[64:67], 0
v_mfma_f32_16x16x32_bf16 v[212:215], v[196:199], v[68:71], v[212:215]
v_mfma_f32_16x16x32_bf16 v[228:231], v[180:183], v[72:75], v[228:231]
s_waitcnt vmcnt(0)
v_mfma_f32_16x16x32_bf16 v[216:219], v[184:187], v[64:67], 0
v_mfma_f32_16x16x32_bf16 v[232:235], v[200:203], v[64:67], 0
v_mfma_f32_16x16x32_bf16 v[216:219], v[200:203], v[68:71], v[216:219]
v_mfma_f32_16x16x32_bf16 v[232:235], v[184:187], v[72:75], v[232:235]
s_nop 1
v_mul_f32 v32, v204, v76
v_mul_f32 v36, v220, v76
v_fmac_f32 v32, v220, v92
v_fma_f32 v36, -v204, v92, v36
v_mul_f32 v33, v205, v77
v_mul_f32 v37, v221, v77
v_fmac_f32 v33, v221, v93
v_fma_f32 v37, -v205, v93, v37
v_mul_f32 v34, v206, v78
v_mul_f32 v38, v222, v78
v_fmac_f32 v34, v222, v94
v_fma_f32 v38, -v206, v94, v38
v_mul_f32 v35, v207, v79
v_mul_f32 v39, v223, v79
v_fmac_f32 v35, v223, v95
v_fma_f32 v39, -v207, v95, v39
v_cvt_pk_bf16_f32 v172, v32, v33
v_cvt_pk_bf16_f32 v173, v34, v35
v_cvt_pk_bf16_f32 v180, v36, v37
v_cvt_pk_bf16_f32 v181, v38, v39
v_mul_f32 v32, v208, v80
v_mul_f32 v36, v224, v80
v_fmac_f32 v32, v224, v96
v_fma_f32 v36, -v208, v96, v36
v_mul_f32 v33, v209, v81
v_mul_f32 v37, v225, v81
v_fmac_f32 v33, v225, v97
v_fma_f32 v37, -v209, v97, v37
v_mul_f32 v34, v210, v82
v_mul_f32 v38, v226, v82
v_fmac_f32 v34, v226, v98
v_fma_f32 v38, -v210, v98, v38
v_mul_f32 v35, v211, v83
v_mul_f32 v39, v227, v83
v_fmac_f32 v35, v227, v99
v_fma_f32 v39, -v211, v99, v39
v_cvt_pk_bf16_f32 v174, v32, v33
v_cvt_pk_bf16_f32 v175, v34, v35
v_cvt_pk_bf16_f32 v182, v36, v37
v_cvt_pk_bf16_f32 v183, v38, v39
v_mul_f32 v32, v212, v84
v_mul_f32 v36, v228, v84
v_fmac_f32 v32, v228, v100
v_fma_f32 v36, -v212, v100, v36
v_mul_f32 v33, v213, v85
v_mul_f32 v37, v229, v85
v_fmac_f32 v33, v229, v101
v_fma_f32 v37, -v213, v101, v37
v_mul_f32 v34, v214, v86
v_mul_f32 v38, v230, v86
v_fmac_f32 v34, v230, v102
v_fma_f32 v38, -v214, v102, v38
v_mul_f32 v35, v215, v87
v_mul_f32 v39, v231, v87
v_fmac_f32 v35, v231, v103
v_fma_f32 v39, -v215, v103, v39
v_cvt_pk_bf16_f32 v176, v32, v33
v_cvt_pk_bf16_f32 v177, v34, v35
v_cvt_pk_bf16_f32 v184, v36, v37
v_cvt_pk_bf16_f32 v185, v38, v39
s_nop 0
v_mul_f32 v32, v216, v88
v_mul_f32 v36, v232, v88
v_fmac_f32 v32, v232, v104
v_fma_f32 v36, -v216, v104, v36
v_mul_f32 v33, v217, v89
v_mul_f32 v37, v233, v89
v_fmac_f32 v33, v233, v105
v_fma_f32 v37, -v217, v105, v37
v_mul_f32 v34, v218, v90
v_mul_f32 v38, v234, v90
v_fmac_f32 v34, v234, v106
v_fma_f32 v38, -v218, v106, v38
v_mul_f32 v35, v219, v91
v_mul_f32 v39, v235, v91
v_fmac_f32 v35, v235, v107
v_fma_f32 v39, -v219, v107, v39
v_cvt_pk_bf16_f32 v178, v32, v33
v_cvt_pk_bf16_f32 v179, v34, v35
v_cvt_pk_bf16_f32 v186, v36, v37
v_cvt_pk_bf16_f32 v187, v38, v39
s_nop 1
v_mfma_f32_16x16x32_bf16 v[236:239], v[172:175], v[108:111], 0
v_mfma_f32_16x16x32_bf16 v[240:243], v[172:175], v[140:143], 0
v_mfma_f32_16x16x32_bf16 v[244:247], v[172:175], v[116:119], 0
v_mfma_f32_16x16x32_bf16 v[248:251], v[172:175], v[148:151], 0
v_mfma_f32_16x16x32_bf16 v[236:239], v[176:179], v[112:115], v[236:239]
v_mfma_f32_16x16x32_bf16 v[240:243], v[176:179], v[144:147], v[240:243]
v_mfma_f32_16x16x32_bf16 v[244:247], v[176:179], v[120:123], v[244:247]
v_mfma_f32_16x16x32_bf16 v[248:251], v[176:179], v[152:155], v[248:251]
v_mfma_f32_16x16x32_bf16 v[236:239], v[180:183], v[124:127], v[236:239]
v_mfma_f32_16x16x32_bf16 v[240:243], v[180:183], v[156:159], v[240:243]
v_mfma_f32_16x16x32_bf16 v[244:247], v[180:183], v[132:135], v[244:247]
v_mfma_f32_16x16x32_bf16 v[248:251], v[180:183], v[164:167], v[248:251]
v_mfma_f32_16x16x32_bf16 v[236:239], v[184:187], v[128:131], v[236:239]
v_mfma_f32_16x16x32_bf16 v[240:243], v[184:187], v[160:163], v[240:243]
v_mfma_f32_16x16x32_bf16 v[244:247], v[184:187], v[136:139], v[244:247]
v_mfma_f32_16x16x32_bf16 v[248:251], v[184:187], v[168:171], v[248:251]
s_mov_b32 s60, 0x7060500
s_mov_b32 s61, 0x7060501
s_mov_b32 s62, 0x7060502
s_mov_b32 s63, 0x7060503
s_nop 1
v_perm_b32 v236, v236, v55, s60
v_perm_b32 v237, v237, v55, s61
v_perm_b32 v238, v238, v55, s62
v_perm_b32 v239, v239, v55, s63
buffer_store_dwordx4 v[236:239], v18, s[44:47], s5 offen offset:0 sc1
v_perm_b32 v240, v240, v55, s60
v_perm_b32 v241, v241, v55, s61
v_perm_b32 v242, v242, v55, s62
v_perm_b32 v243, v243, v55, s63
buffer_store_dwordx4 v[240:243], v18, s[44:47], s5 offen offset:256 sc1
v_perm_b32 v244, v244, v55, s60
v_perm_b32 v245, v245, v55, s61
v_perm_b32 v246, v246, v55, s62
v_perm_b32 v247, v247, v55, s63
buffer_store_dwordx4 v[244:247], v18, s[44:47], s6 offen offset:0 sc1
v_perm_b32 v248, v248, v55, s60
v_perm_b32 v249, v249, v55, s61
v_perm_b32 v250, v250, v55, s62
v_perm_b32 v251, v251, v55, s63
buffer_store_dwordx4 v[248:251], v18, s[44:47], s6 offen offset:256 sc1
s_cmp_eq_u32 s9, 7
s_cbranch_scc0 L_l_nofft
s_mov_b32 s19, 0
s_branch L_po30c
L_po30:
s_mov_b64 exec, 0x0707
buffer_load_dword v56, v47, s[44:47], s0 offen sc1
s_waitcnt vmcnt(0)
L_po30c:
s_mov_b64 exec, 0x0707
v_cmp_ne_u32 vcc, v55, v56
s_mov_b64 exec, -1
s_add_u32 s19, s19, 1
s_cmp_gt_u32 s19, 200000
s_cbranch_scc1 L_po30d
s_cbranch_vccz L_po30d
s_sleep 8
s_branch L_po30
L_po30d:
v_mov_b32 v16, 1
ds_write_b32 v12, v16 offset:72
L_l_nofft:
s_cmp_lt_u32 s16, 2
s_cbranch_scc1 L_l_gq
s_cmp_le_u32 s4, 320
s_cbranch_scc1 L_l_gq
s_lshl_b32 s17, s16, 2
v_add_u32 v16, s17, v12
v_mov_b32 v17, 1
s_waitcnt vmcnt(0)
ds_write_b32 v16, v17 offset:32
ds_write_b32 v16, v17 offset:24
L_l_gq:
s_setprio 3
v_and_b32 v16, 15, v0
v_lshrrev_b32 v17, 4, v0
s_mul_i32 s17, s16, 20
v_mul_u32_u24 v18, 320, v16
v_lshl_add_u32 v18, v17, 2, v18
v_add_u32 v18, 135168, v18
v_bfe_u32 v19, v16, 1, 2
s_mul_i32 s18, s16, 5
s_add_u32 s27, s18, 0
v_xor_b32 v28, s27, v19
v_lshl_add_u32 v28, v28, 4, v18
s_add_u32 s27, s18, 1
v_xor_b32 v29, s27, v19
v_lshl_add_u32 v29, v29, 4, v18
s_add_u32 s27, s18, 2
v_xor_b32 v30, s27, v19
v_lshl_add_u32 v30, v30, 4, v18
s_add_u32 s27, s18, 3
v_xor_b32 v31, s27, v19
v_lshl_add_u32 v31, v31, 4, v18
s_add_u32 s27, s18, 4
v_xor_b32 v32, s27, v19
v_lshl_add_u32 v32, v32, 4, v18
s_mul_i32 s4, s15, 80
s_add_u32 s4, s4, s17
s_cmp_ge_u32 s15, 4
s_cbranch_scc1 L_l_mir
v_lshlrev_b32 v24, 13, v17
v_lshl_add_u32 v24, v16, 4, v24
s_lshl_b32 s5, s4, 13
s_lshl_b32 s17, s20, 9
s_lshl_b32 s18, s31, 8
s_add_u32 s17, s17, s18
s_add_u32 s5, s5, s17
s_add_u32 s5, s5, 14680064
s_mov_b32 s6, 32768
s_branch L_l_mird
L_l_mir:
v_sub_u32 v26, 3, v17
v_lshlrev_b32 v26, 13, v26
v_sub_u32 v24, 15, v16
v_lshl_add_u32 v24, v24, 4, v26
s_cmp_eq_u32 s20, 0
s_cselect_b32 s17, 32, 31
s_lshl_b32 s18, s31, 4
s_sub_u32 s17, s17, s18
v_sub_u32 v25, s17, v16
v_and_b32 v25, 31, v25
v_lshl_add_u32 v25, v25, 4, v26
s_sub_u32 s17, 637, s4
s_lshl_b32 s5, s17, 13
s_add_u32 s5, s5, 14680064
s_sub_u32 s17, 16, s20
s_and_b32 s17, s17, 15
s_lshl_b32 s17, s17, 9
s_add_u32 s8, s5, s17
s_sub_u32 s17, 15, s20
s_lshl_b32 s17, s17, 9
s_sub_u32 s18, 1, s31
s_lshl_b32 s18, s18, 8
s_add_u32 s17, s17, s18
s_add_u32 s5, s5, s17
s_mov_b32 s6, -32768
L_l_mird:
s_mov_b32 s19, 0
L_sp31:
ds_read_b32 v16, v12 offset:16
s_waitcnt lgkmcnt(0)
v_readfirstlane_b32 s27, v16
s_add_u32 s19, s19, 1
s_cmp_gt_u32 s19, 200000
s_cbranch_scc1 L_sp31d
s_cmp_ge_u32 s27, 2
s_cbranch_scc1 L_sp31d
s_sleep 1
s_branch L_sp31
L_sp31d:
ds_read_b32 v172, v28 offset:0
ds_read_b32 v173, v28 offset:5120
ds_read_b32 v174, v28 offset:10240
ds_read_b32 v175, v28 offset:15360
ds_read_b32 v176, v29 offset:0
ds_read_b32 v177, v29 offset:5120
ds_read_b32 v178, v29 offset:10240
ds_read_b32 v179, v29 offset:15360
ds_read_b32 v180, v30 offset:0
ds_read_b32 v181, v30 offset:5120
ds_read_b32 v182, v30 offset:10240
ds_read_b32 v183, v30 offset:15360
ds_read_b32 v184, v31 offset:0
ds_read_b32 v185, v31 offset:5120
ds_read_b32 v186, v31 offset:10240
ds_read_b32 v187, v31 offset:15360
ds_read_b32 v188, v32 offset:0
ds_read_b32 v189, v32 offset:5120
ds_read_b32 v190, v32 offset:10240
ds_read_b32 v191, v32 offset:15360
s_mov_b32 s19, 0
L_sp32:
ds_read_b32 v16, v12 offset:28
s_waitcnt lgkmcnt(0)
v_readfirstlane_b32 s27, v16
s_add_u32 s19, s19, 1
s_cmp_gt_u32 s19, 200000
s_cbranch_scc1 L_sp32d
s_cmp_ge_u32 s27, 1
s_cbranch_scc1 L_sp32d
s_sleep 1
s_branch L_sp32
L_sp32d:
s_mov_b32 s60, 0x0c0c0400
s_mov_b32 s61, 0x04000c0c
s_mov_b32 s19, 0
L_l_yl:
s_mov_b32 s62, s5
s_mov_b32 s63, s8
buffer_load_dwordx4 v[192:195], v24, s[44:47], s62 offen sc1
s_add_u32 s62, s62, s6
buffer_load_dwordx4 v[196:199], v24, s[44:47], s62 offen sc1
s_add_u32 s62, s62, s6
buffer_load_dwordx4 v[200:203], v24, s[44:47], s62 offen sc1
s_add_u32 s62, s62, s6
buffer_load_dwordx4 v[204:207], v24, s[44:47], s62 offen sc1
s_add_u32 s62, s62, s6
buffer_load_dwordx4 v[208:211], v24, s[44:47], s62 offen sc1
s_add_u32 s62, s62, s6
s_cmp_ge_u32 s15, 4
s_cbranch_scc1 L_l_ex
s_waitcnt vmcnt(4)
v_perm_b32 v20, v193, v192, s60
v_perm_b32 v21, v195, v194, s61
v_bitop3_b32 v22, v20, v21, v55 bitop3:0x56
s_waitcnt vmcnt(3)
v_perm_b32 v20, v197, v196, s60
v_perm_b32 v21, v199, v198, s61
v_bitop3_b32 v20, v20, v21, v55 bitop3:0x56
v_or_b32 v22, v22, v20
s_waitcnt vmcnt(2)
v_perm_b32 v20, v201, v200, s60
v_perm_b32 v21, v203, v202, s61
v_bitop3_b32 v20, v20, v21, v55 bitop3:0x56
v_or_b32 v22, v22, v20
s_waitcnt vmcnt(1)
v_perm_b32 v20, v205, v204, s60
v_perm_b32 v21, v207, v206, s61
v_bitop3_b32 v20, v20, v21, v55 bitop3:0x56
v_or_b32 v22, v22, v20
s_waitcnt vmcnt(0)
v_perm_b32 v20, v209, v208, s60
v_perm_b32 v21, v211, v210, s61
v_bitop3_b32 v20, v20, v21, v55 bitop3:0x56
v_or_b32 v22, v22, v20
s_branch L_l_yc
L_l_ex:
buffer_load_dwordx4 v[212:215], v25, s[44:47], s63 offen sc1
s_add_u32 s63, s63, s6
buffer_load_dwordx4 v[216:219], v25, s[44:47], s63 offen sc1
s_add_u32 s63, s63, s6
buffer_load_dwordx4 v[220:223], v25, s[44:47], s63 offen sc1
s_add_u32 s63, s63, s6
buffer_load_dwordx4 v[224:227], v25, s[44:47], s63 offen sc1
s_add_u32 s63, s63, s6
buffer_load_dwordx4 v[228:231], v25, s[44:47], s63 offen sc1
s_add_u32 s63, s63, s6
s_waitcnt vmcnt(9)
v_perm_b32 v20, v193, v192, s60
v_perm_b32 v21, v195, v194, s61
v_bitop3_b32 v22, v20, v21, v55 bitop3:0x56
s_waitcnt vmcnt(8)
v_perm_b32 v20, v197, v196, s60
v_perm_b32 v21, v199, v198, s61
v_bitop3_b32 v20, v20, v21, v55 bitop3:0x56
v_or_b32 v22, v22, v20
s_waitcnt vmcnt(7)
v_perm_b32 v20, v201, v200, s60
v_perm_b32 v21, v203, v202, s61
v_bitop3_b32 v20, v20, v21, v55 bitop3:0x56
v_or_b32 v22, v22, v20
s_waitcnt vmcnt(6)
v_perm_b32 v20, v205, v204, s60
v_perm_b32 v21, v207, v206, s61
v_bitop3_b32 v20, v20, v21, v55 bitop3:0x56
v_or_b32 v22, v22, v20
s_waitcnt vmcnt(5)
v_perm_b32 v20, v209, v208, s60
v_perm_b32 v21, v211, v210, s61
v_bitop3_b32 v20, v20, v21, v55 bitop3:0x56
v_or_b32 v22, v22, v20
s_waitcnt vmcnt(4)
v_perm_b32 v20, v213, v212, s60
v_perm_b32 v21, v215, v214, s61
v_bitop3_b32 v20, v20, v21, v55 bitop3:0x56
v_or_b32 v22, v22, v20
v_mov_b32 v192, v212
v_swap_b32 v193, v195
s_waitcnt vmcnt(3)
v_perm_b32 v20, v217, v216, s60
v_perm_b32 v21, v219, v218, s61
v_bitop3_b32 v20, v20, v21, v55 bitop3:0x56
v_or_b32 v22, v22, v20
v_mov_b32 v196, v216
v_swap_b32 v197, v199
s_waitcnt vmcnt(2)
v_perm_b32 v20, v221, v220, s60
v_perm_b32 v21, v223, v222, s61
v_bitop3_b32 v20, v20, v21, v55 bitop3:0x56
v_or_b32 v22, v22, v20
v_mov_b32 v200, v220
v_swap_b32 v201, v203
s_waitcnt vmcnt(1)
v_perm_b32 v20, v225, v224, s60
v_perm_b32 v21, v227, v226, s61
v_bitop3_b32 v20, v20, v21, v55 bitop3:0x56
v_or_b32 v22, v22, v20
v_mov_b32 v204, v224
v_swap_b32 v205, v207
s_waitcnt vmcnt(0)
v_perm_b32 v20, v229, v228, s60
v_perm_b32 v21, v231, v230, s61
v_bitop3_b32 v20, v20, v21, v55 bitop3:0x56
v_or_b32 v22, v22, v20
v_mov_b32 v208, v228
v_swap_b32 v209, v211
L_l_yc:
v_cmp_ne_u32 vcc, 0, v22
s_add_u32 s19, s19, 1
s_cmp_gt_u32 s19, 200000
s_cbranch_scc1 L_l_yd
s_cbranch_vccz L_l_yd
s_sleep 6
s_branch L_l_yl
L_l_yd:
s_waitcnt vmcnt(0) lgkmcnt(0)
v_add_f32 v172, v172, v192
ds_write_b32 v28, v172 offset:0
v_add_f32 v173, v173, v193
ds_write_b32 v28, v173 offset:5120
v_add_f32 v174, v174, v194
ds_write_b32 v28, v174 offset:10240
v_add_f32 v175, v175, v195
ds_write_b32 v28, v175 offset:15360
v_add_f32 v176, v176, v196
ds_write_b32 v29, v176 offset:0
v_add_f32 v177, v177, v197
ds_write_b32 v29, v177 offset:5120
v_add_f32 v178, v178, v198
ds_write_b32 v29, v178 offset:10240
v_add_f32 v179, v179, v199
ds_write_b32 v29, v179 offset:15360
v_add_f32 v180, v180, v200
ds_write_b32 v30, v180 offset:0
v_add_f32 v181, v181, v201
ds_write_b32 v30, v181 offset:5120
v_add_f32 v182, v182, v202
ds_write_b32 v30, v182 offset:10240
v_add_f32 v183, v183, v203
ds_write_b32 v30, v183 offset:15360
v_add_f32 v184, v184, v204
ds_write_b32 v31, v184 offset:0
v_add_f32 v185, v185, v205
ds_write_b32 v31, v185 offset:5120
v_add_f32 v186, v186, v206
ds_write_b32 v31, v186 offset:10240
v_add_f32 v187, v187, v207
ds_write_b32 v31, v187 offset:15360
v_add_f32 v188, v188, v208
ds_write_b32 v32, v188 offset:0
v_add_f32 v189, v189, v209
ds_write_b32 v32, v189 offset:5120
v_add_f32 v190, v190, v210
ds_write_b32 v32, v190 offset:10240
v_add_f32 v191, v191, v211
ds_write_b32 v32, v191 offset:15360
s_waitcnt lgkmcnt(0)
v_mov_b32 v16, 1
s_mov_b64 exec, 1
ds_add_u32 v12, v16 offset:88
s_mov_b64 exec, -1
s_or_b32 s17, s2, s16
s_cmp_eq_u32 s17, 0
s_cbranch_scc0 L_l_noep
v_mov_b32 v8, 0
s_mov_b64 exec, 1
buffer_store_dword v55, v8, s[44:47], 0 offen sc1
s_mov_b64 exec, -1
L_l_noep:
s_endpgm
L_hp_D:
s_barrier
s_add_u32 m0, s50, 0
s_nop 0
buffer_load_dwordx4 v5, s[76:79], s48 offen lds
s_add_u32 m0, s50, 1024
s_add_u32 s48, s48, 10240
buffer_load_dwordx4 v5, s[76:79], s48 offen lds
s_add_u32 m0, s50, 2048
s_add_u32 s48, s48, 10240
buffer_load_dwordx4 v5, s[76:79], s48 offen lds
s_add_u32 m0, s50, 3072
s_add_u32 s48, s48, 10240
buffer_load_dwordx4 v5, s[76:79], s48 offen lds
s_cmp_eq_u32 s62, 1
s_cbranch_scc0 L_hp_d3D
s_add_u32 m0, s52, 0
s_nop 0
buffer_load_dwordx4 v5, s[76:79], s49 offen lds
s_add_u32 m0, s52, 1024
s_add_u32 s49, s49, 10240
buffer_load_dwordx4 v5, s[76:79], s49 offen lds
s_add_u32 m0, s52, 2048
s_add_u32 s49, s49, 10240
buffer_load_dwordx4 v5, s[76:79], s49 offen lds
s_add_u32 m0, s52, 3072
s_add_u32 s49, s49, 10240
buffer_load_dwordx4 v5, s[76:79], s49 offen lds
L_hp_d3D:
s_cmp_eq_u32 s16, 0
s_cbranch_scc0 L_on33
ds_read_b32 v24, v9 offset:256
s_lshl_b32 s17, s26, 4
s_add_u32 s17, s17, s29
s_lshl_b32 s17, s17, 7
s_add_u32 s17, s17, 65536
s_mov_b32 exec_hi, 0
s_waitcnt lgkmcnt(0)
buffer_store_dword v24, v7, s[44:47], s17 offen sc1
s_mov_b64 exec, -1
L_on33:
s_barrier
s_barrier
s_waitcnt vmcnt(0)
v_lshrrev_b32 v30, 2, v0
v_lshlrev_b32 v30, 7, v30
v_and_b32 v31, 3, v0
v_lshl_add_u32 v30, v31, 3, v30
v_add_u32 v30, s50, v30
v_lshlrev_b32 v31, 4, v0
ds_read_b64_tr_b16 v[32:33], v30 offset:0
ds_read_b64_tr_b16 v[34:35], v30 offset:2048
ds_read_b64_tr_b16 v[36:37], v30 offset:32
ds_read_b64_tr_b16 v[38:39], v30 offset:2080
ds_read_b64_tr_b16 v[40:41], v30 offset:64
ds_read_b64_tr_b16 v[42:43], v30 offset:2112
ds_read_b64_tr_b16 v[44:45], v30 offset:96
ds_read_b64_tr_b16 v[46:47], v30 offset:2144
s_waitcnt lgkmcnt(6)
buffer_store_dwordx4 v[32:35], v31, s[44:47], s51 offen offset:0 sc1
s_waitcnt lgkmcnt(4)
buffer_store_dwordx4 v[36:39], v31, s[44:47], s51 offen offset:1024 sc1
s_waitcnt lgkmcnt(2)
buffer_store_dwordx4 v[40:43], v31, s[44:47], s51 offen offset:2048 sc1
s_waitcnt lgkmcnt(0)
buffer_store_dwordx4 v[44:47], v31, s[44:47], s51 offen offset:3072 sc1
s_cmp_eq_u32 s62, 1
s_cbranch_scc0 L_hp_f3D
v_lshrrev_b32 v30, 2, v0
v_lshlrev_b32 v30, 7, v30
v_and_b32 v31, 3, v0
v_lshl_add_u32 v30, v31, 3, v30
v_add_u32 v30, s52, v30
v_lshlrev_b32 v31, 4, v0
ds_read_b64_tr_b16 v[212:213], v30 offset:0
ds_read_b64_tr_b16 v[214:215], v30 offset:2048
ds_read_b64_tr_b16 v[216:217], v30 offset:32
ds_read_b64_tr_b16 v[218:219], v30 offset:2080
ds_read_b64_tr_b16 v[220:221], v30 offset:64
ds_read_b64_tr_b16 v[222:223], v30 offset:2112
ds_read_b64_tr_b16 v[224:225], v30 offset:96
ds_read_b64_tr_b16 v[226:227], v30 offset:2144
s_waitcnt lgkmcnt(6)
buffer_store_dwordx4 v[212:215], v31, s[44:47], s53 offen offset:0 sc1
s_waitcnt lgkmcnt(4)
buffer_store_dwordx4 v[216:219], v31, s[44:47], s53 offen offset:1024 sc1
s_waitcnt lgkmcnt(2)
buffer_store_dwordx4 v[220:223], v31, s[44:47], s53 offen offset:2048 sc1
s_waitcnt lgkmcnt(0)
buffer_store_dwordx4 v[224:227], v31, s[44:47], s53 offen offset:3072 sc1
L_hp_f3D:
s_waitcnt vmcnt(0)
s_barrier
s_cmp_eq_u32 s16, 0
s_cbranch_scc0 L_on34
s_mov_b32 exec_hi, 0
buffer_store_dword v55, v7, s[44:47], s0 offen sc1
s_mov_b64 exec, -1
L_on34:
s_barrier
s_cmp_eq_u32 s16, 1
s_cbranch_scc0 L_on35
s_lshl_b32 s17, s26, 11
s_add_u32 s17, s17, 65536
buffer_load_dwordx4 v[56:59], v8, s[44:47], s17 offen sc1
buffer_load_dwordx4 v[60:63], v8, s[44:47], s17 offen offset:1024 sc1
s_lshl_b32 s17, s20, 11
s_lshl_b32 s18, s31, 8
s_add_u32 s17, s17, s18
s_add_u32 s17, s17, 65536
buffer_load_dwordx4 v[48:51], v52, s[44:47], s17 offen sc1
L_on35:
s_cmp_eq_u32 s16, 0
s_cbranch_scc0 L_on36
s_mov_b32 exec_lo, 0x1ffffff
s_mov_b32 exec_hi, 0x1ffffff
buffer_load_dword v54, v53, s[44:47], s1 offen sc1
s_mov_b64 exec, -1
L_on36:
s_lshl_b32 s17, s31, 10
s_lshl_b32 s18, s20, 2
s_add_u32 s17, s17, s18
s_mul_i32 s17, s17, 1280
s_mul_i32 s18, s15, 160
s_add_u32 s17, s17, s18
buffer_load_dwordx4 v[172:175], v240, s[36:39], s17 offen
buffer_load_dwordx4 v[180:183], v241, s[36:39], s17 offen
buffer_load_dwordx4 v[188:191], v242, s[36:39], s17 offen
buffer_load_dwordx4 v[196:199], v243, s[36:39], s17 offen
buffer_load_dwordx4 v[204:207], v244, s[36:39], s17 offen
s_waitcnt vmcnt(5)
s_cmp_eq_u32 s16, 1
s_cbranch_scc0 L_on37
s_mov_b32 s19, 0
s_mov_b32 s17, 0x01000100
L_l_scD:
v_cmp_ne_u32 vcc, v55, v59
v_cmp_ne_u32 s[68:69], v55, v63
v_cmp_ne_u32 s[70:71], v55, v51
s_add_u32 s19, s19, 1
s_cmp_gt_u32 s19, 200000
s_cbranch_scc1 L_l_scdD
s_or_b64 vcc, vcc, s[68:69]
s_or_b64 vcc, vcc, s[70:71]
s_cbranch_vccz L_l_scdD
s_sleep 4
s_lshl_b32 s17, s26, 11
s_add_u32 s17, s17, 65536
buffer_load_dwordx4 v[56:59], v8, s[44:47], s17 offen sc1
buffer_load_dwordx4 v[60:63], v8, s[44:47], s17 offen offset:1024 sc1
s_lshl_b32 s17, s20, 11
s_lshl_b32 s18, s31, 8
s_add_u32 s17, s17, s18
s_add_u32 s17, s17, 65536
buffer_load_dwordx4 v[48:51], v52, s[44:47], s17 offen sc1
s_mov_b32 s17, 0x01000100
s_waitcnt vmcnt(0)
s_branch L_l_scD
L_l_scdD:
v_perm_b32 v40, v56, v56, s17
v_lshrrev_b32 v41, 16, v56
v_perm_b32 v42, v60, v60, s17
v_lshrrev_b32 v43, 16, v60
ds_write_b32 v253, v57
ds_write_b32 v253, v61 offset:256
ds_write_b32 v253, v58 offset:512
ds_write_b32 v253, v62 offset:768
ds_write_b32 v253, v49 offset:1536
ds_write_b64 v252, v[40:41]
ds_write_b64 v252, v[42:43] offset:512
L_on37:
s_cmp_eq_u32 s16, 0
s_cbranch_scc0 L_on38
s_mov_b32 s19, 0
s_branch L_po39c
L_po39:
s_mov_b32 exec_lo, 0x1ffffff
s_mov_b32 exec_hi, 0x1ffffff
buffer_load_dword v54, v53, s[44:47], s1 offen sc1
s_waitcnt vmcnt(0)
L_po39c:
s_mov_b32 exec_lo, 0x1ffffff
s_mov_b32 exec_hi, 0x1ffffff
v_cmp_ne_u32 vcc, v55, v54
s_mov_b64 exec, -1
s_add_u32 s19, s19, 1
s_cmp_gt_u32 s19, 200000
s_cbranch_scc1 L_po39d
s_cbranch_vccz L_po39d
s_sleep 4
s_branch L_po39
L_po39d:
L_on38:
s_cmp_eq_u32 s16, 0
s_cbranch_scc0 L_on40
v_mov_b32 v16, 1
ds_write_b32 v12, v16 offset:12
L_on40:
s_waitcnt lgkmcnt(0)
s_barrier
s_branch L_hp_gap
L_hp_4:
s_barrier
s_add_u32 m0, s50, 0
s_nop 0
buffer_load_dwordx4 v5, s[76:79], s48 offen lds
s_add_u32 m0, s50, 1024
s_add_u32 s48, s48, 10240
buffer_load_dwordx4 v5, s[76:79], s48 offen lds
s_add_u32 m0, s50, 2048
s_add_u32 s48, s48, 10240
buffer_load_dwordx4 v5, s[76:79], s48 offen lds
s_add_u32 m0, s50, 3072
s_add_u32 s48, s48, 10240
buffer_load_dwordx4 v5, s[76:79], s48 offen lds
s_cmp_eq_u32 s16, 0
s_cbranch_scc0 L_on41
ds_read_b32 v24, v9 offset:256
s_lshl_b32 s17, s26, 4
s_add_u32 s17, s17, s29
s_lshl_b32 s17, s17, 7
s_add_u32 s17, s17, 65536
s_mov_b32 exec_hi, 0
s_waitcnt lgkmcnt(0)
buffer_store_dword v24, v7, s[44:47], s17 offen sc1
s_mov_b64 exec, -1
L_on41:
ds_read_b64_tr_b16 v[16:17], v232 offset:16384
ds_read_b64_tr_b16 v[18:19], v232 offset:17408
ds_read_b64_tr_b16 v[20:21], v232 offset:24576
ds_read_b64_tr_b16 v[22:23], v232 offset:25600
ds_read_b64_tr_b16 v[24:25], v233 offset:16384
ds_read_b64_tr_b16 v[26:27], v233 offset:17408
ds_read_b64_tr_b16 v[28:29], v233 offset:24576
ds_read_b64_tr_b16 v[30:31], v233 offset:25600
ds_read_b64_tr_b16 v[32:33], v234 offset:16384
ds_read_b64_tr_b16 v[34:35], v234 offset:17408
ds_read_b64_tr_b16 v[36:37], v234 offset:24576
ds_read_b64_tr_b16 v[38:39], v234 offset:25600
ds_read_b64_tr_b16 v[40:41], v235 offset:16384
ds_read_b64_tr_b16 v[42:43], v235 offset:17408
ds_read_b64_tr_b16 v[44:45], v235 offset:24576
ds_read_b64_tr_b16 v[46:47], v235 offset:25600
s_mul_i32 s18, s64, 640
s_add_u32 s17, s66, s18
s_waitcnt lgkmcnt(0)
v_mfma_f32_16x16x32_bf16 v[212:215], v[228:231], v[16:19], 0
v_mfma_f32_16x16x32_bf16 v[216:219], v[228:231], v[24:27], 0
v_mfma_f32_16x16x32_bf16 v[220:223], v[228:231], v[32:35], 0
v_mfma_f32_16x16x32_bf16 v[224:227], v[228:231], v[40:43], 0
v_mfma_f32_16x16x32_bf16 v[212:215], v[228:231], v[20:23], v[212:215]
v_mfma_f32_16x16x32_bf16 v[216:219], v[228:231], v[28:31], v[216:219]
v_mfma_f32_16x16x32_bf16 v[220:223], v[228:231], v[36:39], v[220:223]
v_mfma_f32_16x16x32_bf16 v[224:227], v[228:231], v[44:47], v[224:227]
s_nop 7
v_cndmask_b32 v212, v216, v212, vcc
v_cndmask_b32 v220, v224, v220, vcc
v_perm_b32 v212, v212, v55, v238
v_perm_b32 v220, v220, v55, v238
s_mov_b32 exec_hi, 0
buffer_store_dword v212, v7, s[44:47], s17 offen sc1
buffer_store_dword v220, v7, s[44:47], s17 offen offset:256 sc1
s_mov_b64 exec, -1
s_barrier
s_barrier
s_waitcnt vmcnt(0)
v_lshrrev_b32 v30, 2, v0
v_lshlrev_b32 v30, 7, v30
v_and_b32 v31, 3, v0
v_lshl_add_u32 v30, v31, 3, v30
v_add_u32 v30, s50, v30
v_lshlrev_b32 v31, 4, v0
ds_read_b64_tr_b16 v[32:33], v30 offset:0
ds_read_b64_tr_b16 v[34:35], v30 offset:2048
ds_read_b64_tr_b16 v[36:37], v30 offset:32
ds_read_b64_tr_b16 v[38:39], v30 offset:2080
ds_read_b64_tr_b16 v[40:41], v30 offset:64
ds_read_b64_tr_b16 v[42:43], v30 offset:2112
ds_read_b64_tr_b16 v[44:45], v30 offset:96
ds_read_b64_tr_b16 v[46:47], v30 offset:2144
s_waitcnt lgkmcnt(6)
buffer_store_dwordx4 v[32:35], v31, s[44:47], s51 offen offset:0 sc1
s_waitcnt lgkmcnt(4)
buffer_store_dwordx4 v[36:39], v31, s[44:47], s51 offen offset:1024 sc1
s_waitcnt lgkmcnt(2)
buffer_store_dwordx4 v[40:43], v31, s[44:47], s51 offen offset:2048 sc1
s_waitcnt lgkmcnt(0)
buffer_store_dwordx4 v[44:47], v31, s[44:47], s51 offen offset:3072 sc1
s_barrier
s_waitcnt vmcnt(0)
s_barrier
s_cmp_eq_u32 s16, 0
s_cbranch_scc0 L_on42
s_mov_b32 exec_hi, 0
buffer_store_dword v55, v7, s[44:47], s0 offen sc1
s_mov_b64 exec, -1
L_on42:
s_cmp_eq_u32 s16, 1
s_cbranch_scc0 L_on43
s_lshl_b32 s17, s26, 11
s_add_u32 s17, s17, 65536
buffer_load_dwordx4 v[56:59], v8, s[44:47], s17 offen sc1
buffer_load_dwordx4 v[60:63], v8, s[44:47], s17 offen offset:1024 sc1
s_lshl_b32 s17, s20, 11
s_lshl_b32 s18, s31, 8
s_add_u32 s17, s17, s18
s_add_u32 s17, s17, 65536
buffer_load_dwordx4 v[48:51], v52, s[44:47], s17 offen sc1
L_on43:
s_cmp_eq_u32 s16, 0
s_cbranch_scc0 L_on44
s_mul_i32 s17, s29, 6400
s_add_u32 s17, s17, 393216
s_mov_b32 m0, 147456
s_add_u32 s18, s17, 4096
buffer_load_dwordx4 v8, s[44:47], s17 offen offset:0 sc1 lds
buffer_load_dwordx4 v8, s[44:47], s17 offen offset:1024 sc1 lds
buffer_load_dwordx4 v8, s[44:47], s17 offen offset:2048 sc1 lds
buffer_load_dwordx4 v8, s[44:47], s17 offen offset:3072 sc1 lds
s_mov_b32 m0, 151552
s_nop 0
buffer_load_dwordx4 v8, s[44:47], s18 offen offset:0 sc1 lds
buffer_load_dwordx4 v8, s[44:47], s18 offen offset:1024 sc1 lds
buffer_load_dwordx4 v8, s[44:47], s18 offen offset:2048 sc1 lds
L_on44:
s_barrier
s_waitcnt vmcnt(0)
s_barrier
ds_read_b32 v16, v239 offset:0
ds_read_b32 v17, v239 offset:640
ds_read_b32 v18, v239 offset:1280
ds_read_b32 v19, v239 offset:1920
ds_read_b32 v20, v239 offset:2560
ds_read_b32 v21, v239 offset:256
ds_read_b32 v22, v239 offset:896
ds_read_b32 v23, v239 offset:1536
ds_read_b32 v24, v239 offset:2176
ds_read_b32 v25, v239 offset:2816
s_cmp_eq_u32 s16, 1
s_cbranch_scc0 L_on45
s_mov_b32 s19, 0
s_mov_b32 s17, 0x01000100
L_l_sc4:
v_cmp_ne_u32 vcc, v55, v59
v_cmp_ne_u32 s[68:69], v55, v63
v_cmp_ne_u32 s[70:71], v55, v51
s_add_u32 s19, s19, 1
s_cmp_gt_u32 s19, 200000
s_cbranch_scc1 L_l_scd4
s_or_b64 vcc, vcc, s[68:69]
s_or_b64 vcc, vcc, s[70:71]
s_cbranch_vccz L_l_scd4
s_sleep 4
s_lshl_b32 s17, s26, 11
s_add_u32 s17, s17, 65536
buffer_load_dwordx4 v[56:59], v8, s[44:47], s17 offen sc1
buffer_load_dwordx4 v[60:63], v8, s[44:47], s17 offen offset:1024 sc1
s_lshl_b32 s17, s20, 11
s_lshl_b32 s18, s31, 8
s_add_u32 s17, s17, s18
s_add_u32 s17, s17, 65536
buffer_load_dwordx4 v[48:51], v52, s[44:47], s17 offen sc1
s_mov_b32 s17, 0x01000100
s_waitcnt vmcnt(0)
s_branch L_l_sc4
L_l_scd4:
v_perm_b32 v40, v56, v56, s17
v_lshrrev_b32 v41, 16, v56
v_perm_b32 v42, v60, v60, s17
v_lshrrev_b32 v43, 16, v60
ds_write_b32 v253, v57
ds_write_b32 v253, v61 offset:256
ds_write_b32 v253, v58 offset:512
ds_write_b32 v253, v62 offset:768
ds_write_b32 v253, v49 offset:1536
ds_write_b64 v252, v[40:41]
ds_write_b64 v252, v[42:43] offset:512
L_on45:
s_barrier
s_cmp_eq_u32 s16, 0
s_cbranch_scc0 L_on46
s_mov_b32 exec_lo, 0x1ffffff
s_mov_b32 exec_hi, 0x1ffffff
buffer_load_dword v54, v53, s[44:47], s1 offen sc1
s_mov_b64 exec, -1
L_on46:
s_mov_b32 s19, 0
L_ck47:
s_waitcnt lgkmcnt(0)
v_xor_b32 v38, v250, v16
v_xor_b32 v39, v250, v17
v_xor_b32 v40, v250, v18
v_xor_b32 v41, v250, v19
v_xor_b32 v42, v250, v20
v_or3_b32 v38, v38, v39, v40
v_add_f32 v39, v16, v17
v_or3_b32 v38, v38, v41, v42
v_add_f32 v40, v18, v19
v_and_b32 v38, 0xff, v38
v_add_f32 v39, v39, v20
v_cmp_ne_u32 vcc, 0, v38
v_add_f32 v39, v39, v40
s_add_u32 s19, s19, 1
s_cmp_gt_u32 s19, 200000
s_cbranch_scc1 L_ck47d
s_cbranch_vccz L_ck47d
s_sleep 4
s_mul_i32 s17, s29, 6400
s_add_u32 s17, s17, 393216
s_mov_b32 m0, 147456
s_add_u32 s18, s17, 4096
buffer_load_dwordx4 v8, s[44:47], s17 offen offset:0 sc1 lds
buffer_load_dwordx4 v8, s[44:47], s17 offen offset:1024 sc1 lds
buffer_load_dwordx4 v8, s[44:47], s17 offen offset:2048 sc1 lds
buffer_load_dwordx4 v8, s[44:47], s17 offen offset:3072 sc1 lds
s_mov_b32 m0, 151552
s_nop 0
buffer_load_dwordx4 v8, s[44:47], s18 offen offset:0 sc1 lds
buffer_load_dwordx4 v8, s[44:47], s18 offen offset:1024 sc1 lds
buffer_load_dwordx4 v8, s[44:47], s18 offen offset:2048 sc1 lds
s_waitcnt vmcnt(0)
ds_read_b32 v16, v239 offset:0
ds_read_b32 v17, v239 offset:640
ds_read_b32 v18, v239 offset:1280
ds_read_b32 v19, v239 offset:1920
ds_read_b32 v20, v239 offset:2560
s_branch L_ck47
L_ck47d:
v_mov_b32 v40, v39
s_nop 1
v_permlane32_swap_b32 v39, v40
s_nop 1
v_add_f32 v39, v39, v40
v_cvt_pk_bf16_f32 v40, v39, v39
v_lshlrev_b32 v40, 16, v40
v_sub_f32 v39, v39, v40
v_cvt_pk_bf16_f32 v39, v40, v39
s_mov_b32 exec_hi, 0
ds_write_b32 v251, v39 offset:0
s_mov_b64 exec, -1
s_barrier
s_mov_b32 s19, 0
L_ck48:
s_waitcnt lgkmcnt(0)
v_xor_b32 v38, v250, v21
v_xor_b32 v39, v250, v22
v_xor_b32 v40, v250, v23
v_xor_b32 v41, v250, v24
v_xor_b32 v42, v250, v25
v_or3_b32 v38, v38, v39, v40
v_add_f32 v39, v21, v22
v_or3_b32 v38, v38, v41, v42
v_add_f32 v40, v23, v24
v_and_b32 v38, 0xff, v38
v_add_f32 v39, v39, v25
v_cmp_ne_u32 vcc, 0, v38
v_add_f32 v39, v39, v40
s_add_u32 s19, s19, 1
s_cmp_gt_u32 s19, 200000
s_cbranch_scc1 L_ck48d
s_cbranch_vccz L_ck48d
s_sleep 4
s_mul_i32 s17, s29, 6400
s_add_u32 s17, s17, 393216
s_mov_b32 m0, 147456
s_add_u32 s18, s17, 4096
buffer_load_dwordx4 v8, s[44:47], s17 offen offset:0 sc1 lds
buffer_load_dwordx4 v8, s[44:47], s17 offen offset:1024 sc1 lds
buffer_load_dwordx4 v8, s[44:47], s17 offen offset:2048 sc1 lds
buffer_load_dwordx4 v8, s[44:47], s17 offen offset:3072 sc1 lds
s_mov_b32 m0, 151552
s_nop 0
buffer_load_dwordx4 v8, s[44:47], s18 offen offset:0 sc1 lds
buffer_load_dwordx4 v8, s[44:47], s18 offen offset:1024 sc1 lds
buffer_load_dwordx4 v8, s[44:47], s18 offen offset:2048 sc1 lds
s_waitcnt vmcnt(0)
ds_read_b32 v21, v239 offset:256
ds_read_b32 v22, v239 offset:896
ds_read_b32 v23, v239 offset:1536
ds_read_b32 v24, v239 offset:2176
ds_read_b32 v25, v239 offset:2816
s_branch L_ck48
L_ck48d:
v_mov_b32 v40, v39
s_nop 1
v_permlane32_swap_b32 v39, v40
s_nop 1
v_add_f32 v39, v39, v40
v_cvt_pk_bf16_f32 v40, v39, v39
v_lshlrev_b32 v40, 16, v40
v_sub_f32 v39, v39, v40
v_cvt_pk_bf16_f32 v39, v40, v39
s_mov_b32 exec_hi, 0
ds_write_b32 v251, v39 offset:2048
s_mov_b64 exec, -1
s_waitcnt vmcnt(0)
s_cmp_eq_u32 s16, 0
s_cbranch_scc0 L_on49
s_mov_b32 s19, 0
s_branch L_po50c
L_po50:
s_mov_b32 exec_lo, 0x1ffffff
s_mov_b32 exec_hi, 0x1ffffff
buffer_load_dword v54, v53, s[44:47], s1 offen sc1
s_waitcnt vmcnt(0)
L_po50c:
s_mov_b32 exec_lo, 0x1ffffff
s_mov_b32 exec_hi, 0x1ffffff
v_cmp_ne_u32 vcc, v55, v54
s_mov_b64 exec, -1
s_add_u32 s19, s19, 1
s_cmp_gt_u32 s19, 200000
s_cbranch_scc1 L_po50d
s_cbranch_vccz L_po50d
s_sleep 4
s_branch L_po50
L_po50d:
L_on49:
s_waitcnt lgkmcnt(0)
s_barrier
s_lshl_b32 s17, s31, 10
s_lshl_b32 s18, s20, 2
s_add_u32 s17, s17, s18
s_mul_i32 s17, s17, 1280
s_mul_i32 s18, s15, 160
s_add_u32 s17, s17, s18
buffer_load_dwordx4 v[172:175], v240, s[36:39], s17 offen
buffer_load_dwordx4 v[180:183], v241, s[36:39], s17 offen
buffer_load_dwordx4 v[188:191], v242, s[36:39], s17 offen
buffer_load_dwordx4 v[196:199], v243, s[36:39], s17 offen
buffer_load_dwordx4 v[204:207], v244, s[36:39], s17 offen
s_branch L_hp_gap
L_gstart:
s_lshl3_add_u32 s29, s23, s25
v_and_b32 v11, 31, v0
v_lshrrev_b32 v12, 5, v0
s_mov_b32 s17, 81920
v_mul_lo_u32 v13, v12, s17
v_lshl_add_u32 v13, v11, 4, v13
s_and_b32 s17, s29, 3
s_lshl_b32 s17, s17, 2
s_add_u32 s17, s17, s16
s_lshl_b32 s48, s17, 1
s_lshr_b32 s49, s29, 2
s_lshl_b32 s50, s26, 2
s_add_u32 s50, s50, s49
s_lshl_b32 s17, s48, 6
s_add_u32 s17, s17, s50
s_mul_i32 s51, s17, 1280

s_waitcnt lgkmcnt(0)
s_mov_b32 s36, s4
s_mov_b32 s37, s5
s_mov_b32 s38, 2621440
s_mov_b32 s39, 0x20000
s_mov_b32 s44, s12
s_mov_b32 s45, s13
s_mov_b32 s46, 18874368
s_mov_b32 s47, 0x20000
s_load_dword s14, s[12:13], 0
buffer_load_dwordx4 v[20:23], v13, s[36:39], s51 offen
buffer_load_dwordx4 v[24:27], v13, s[36:39], s51 offen offset:512
s_mov_b32 exec_lo, 0xffff
s_mov_b32 exec_hi, 0xffff
buffer_load_dwordx4 v[28:31], v13, s[36:39], s51 offen offset:1024
s_mov_b64 exec, -1

v_and_b32 v64, 15, v0
s_and_b32 s17, s16, 1
s_lshl_b32 s18, s17, 4
v_add_u32 v66, s18, v64
v_cvt_f32_u32 v66, v66
v_lshlrev_b32 v64, 1, v64
s_lshr_b32 s18, s16, 1
v_add_u32 v64, s18, v64
v_cvt_f32_u32 v64, v64
v_lshrrev_b32 v65, 4, v0
v_lshlrev_b32 v67, 2, v65
s_lshl_b32 s17, s17, 5
v_add_u32 v68, s17, v67
v_cvt_f32_u32 v68, v68
v_cvt_f32_u32 v67, v67
v_mul_f32 v69, 0x3c800000, v64
v_mul_f32 v70, v69, v68
v_lshlrev_b32 v71, 4, v0
v_add_u32 v71, 114688, v71
v_fmamk_f32 v73, v69, 0x00000000, v70
v_cos_f32 v80, v73
v_sin_f32 v88, v73
v_fmamk_f32 v73, v69, 0x3f800000, v70
v_cos_f32 v81, v73
v_sin_f32 v89, v73
v_fmamk_f32 v73, v69, 0x40000000, v70
v_cos_f32 v82, v73
v_sin_f32 v90, v73
v_fmamk_f32 v73, v69, 0x40400000, v70
v_cos_f32 v83, v73
v_sin_f32 v91, v73
v_fmamk_f32 v73, v69, 0x41800000, v70
v_cos_f32 v84, v73
v_sin_f32 v92, v73
v_fmamk_f32 v73, v69, 0x41880000, v70
v_cos_f32 v85, v73
v_sin_f32 v93, v73
v_fmamk_f32 v73, v69, 0x41900000, v70
v_cos_f32 v86, v73
v_sin_f32 v94, v73
v_fmamk_f32 v73, v69, 0x41980000, v70
v_cos_f32 v87, v73
v_sin_f32 v95, v73
s_lshl_b32 s17, s16, 11
v_add_u32 v72, s17, v71
v_cvt_pk_bf16_f32 v96, v80, v81
v_cvt_pk_bf16_f32 v100, v88, v89
v_cvt_pk_bf16_f32 v97, v82, v83
v_cvt_pk_bf16_f32 v101, v90, v91
v_cvt_pk_bf16_f32 v98, v84, v85
v_cvt_pk_bf16_f32 v102, v92, v93
v_cvt_pk_bf16_f32 v99, v86, v87
v_cvt_pk_bf16_f32 v103, v94, v95
ds_write_b128 v72, v[96:99]
ds_write_b128 v72, v[100:103] offset:1024
s_cmp_ge_u32 s16, 2
s_cbranch_scc1 L_g_cf1
v_mul_f32 v69, 0x3a000000, v66
v_mul_f32 v70, v69, v67
s_lshl_b32 s17, s16, 13
s_add_u32 s17, s17, 8192
v_add_u32 v72, s17, v71
v_fmamk_f32 v73, v69, 0x00000000, v70
v_cos_f32 v80, v73
v_sin_f32 v84, v73
v_fmamk_f32 v73, v69, 0x3f800000, v70
v_cos_f32 v81, v73
v_sin_f32 v85, v73
v_fmamk_f32 v73, v69, 0x40000000, v70
v_cos_f32 v82, v73
v_sin_f32 v86, v73
v_fmamk_f32 v73, v69, 0x40400000, v70
v_cos_f32 v83, v73
v_sin_f32 v87, v73
s_nop 0
ds_write_b128 v72, v[80:83] offset:0
ds_write_b128 v72, v[84:87] offset:4096
v_fmamk_f32 v73, v69, 0x41800000, v70
v_cos_f32 v88, v73
v_sin_f32 v92, v73
v_fmamk_f32 v73, v69, 0x41880000, v70
v_cos_f32 v89, v73
v_sin_f32 v93, v73
v_fmamk_f32 v73, v69, 0x41900000, v70
v_cos_f32 v90, v73
v_sin_f32 v94, v73
v_fmamk_f32 v73, v69, 0x41980000, v70
v_cos_f32 v91, v73
v_sin_f32 v95, v73
s_nop 0
ds_write_b128 v72, v[88:91] offset:1024
ds_write_b128 v72, v[92:95] offset:5120
v_fmamk_f32 v73, v69, 0x42000000, v70
v_cos_f32 v80, v73
v_sin_f32 v84, v73
v_fmamk_f32 v73, v69, 0x42040000, v70
v_cos_f32 v81, v73
v_sin_f32 v85, v73
v_fmamk_f32 v73, v69, 0x42080000, v70
v_cos_f32 v82, v73
v_sin_f32 v86, v73
v_fmamk_f32 v73, v69, 0x420c0000, v70
v_cos_f32 v83, v73
v_sin_f32 v87, v73
s_nop 0
ds_write_b128 v72, v[80:83] offset:2048
ds_write_b128 v72, v[84:87] offset:6144
v_fmamk_f32 v73, v69, 0x42400000, v70
v_cos_f32 v88, v73
v_sin_f32 v92, v73
v_fmamk_f32 v73, v69, 0x42440000, v70
v_cos_f32 v89, v73
v_sin_f32 v93, v73
v_fmamk_f32 v73, v69, 0x42480000, v70
v_cos_f32 v90, v73
v_sin_f32 v94, v73
v_fmamk_f32 v73, v69, 0x424c0000, v70
v_cos_f32 v91, v73
v_sin_f32 v95, v73
s_nop 0
ds_write_b128 v72, v[88:91] offset:3072
ds_write_b128 v72, v[92:95] offset:7168
s_branch L_g_cdone
L_g_cf1:
v_mul_f32 v69, 0x3d000000, v66
v_mul_f32 v70, v69, v67
s_lshl_b32 s17, s16, 11
s_add_u32 s17, s17, 20480
v_add_u32 v72, s17, v71
v_fmamk_f32 v73, v69, 0x00000000, v70
v_cos_f32 v80, v73
v_sin_f32 v88, v73
v_fmamk_f32 v73, v69, 0x3f800000, v70
v_cos_f32 v81, v73
v_sin_f32 v89, v73
v_fmamk_f32 v73, v69, 0x40000000, v70
v_cos_f32 v82, v73
v_sin_f32 v90, v73
v_fmamk_f32 v73, v69, 0x40400000, v70
v_cos_f32 v83, v73
v_sin_f32 v91, v73
v_fmamk_f32 v73, v69, 0x41800000, v70
v_cos_f32 v84, v73
v_sin_f32 v92, v73
v_fmamk_f32 v73, v69, 0x41880000, v70
v_cos_f32 v85, v73
v_sin_f32 v93, v73
v_fmamk_f32 v73, v69, 0x41900000, v70
v_cos_f32 v86, v73
v_sin_f32 v94, v73
v_fmamk_f32 v73, v69, 0x41980000, v70
v_cos_f32 v87, v73
v_sin_f32 v95, v73
s_nop 0
v_cvt_pk_bf16_f32 v96, v80, v81
v_cvt_pk_bf16_f32 v100, v88, v89
v_cvt_pk_bf16_f32 v97, v82, v83
v_cvt_pk_bf16_f32 v101, v90, v91
v_cvt_pk_bf16_f32 v98, v84, v85
v_cvt_pk_bf16_f32 v102, v92, v93
v_cvt_pk_bf16_f32 v99, v86, v87
v_cvt_pk_bf16_f32 v103, v94, v95
ds_write_b128 v72, v[96:99]
ds_write_b128 v72, v[100:103] offset:1024
L_g_cdone:
s_cmp_eq_u32 s23, 0
s_mov_b32 s28, 0x337ace08
s_cselect_b32 s28, 0x1cc51460, s28
s_cselect_b32 s30, 5, 2
s_mul_i32 s27, s25, 5
s_lshr_b32 s28, s28, s27
s_and_b32 s28, s28, 31
s_lshl_b32 s28, s28, 1
s_bitcmp1_b32 s30, s25
s_cselect_b32 s30, 4, -1
s_add_u32 s30, s30, s28
s_cmp_lt_u32 s25, 3
s_cselect_b32 s33, 1, s34
s_lshl3_add_u32 s29, s23, s25
s_and_b32 s15, s21, 3
s_lshl2_add_u32 s15, s23, s15
s_bfe_u32 s31, s21, 0x10002
s_mov_b32 s20, s26
s_lshl1_add_u32 s27, s26, s23
s_mul_i32 s21, s27, 3
s_add_u32 s21, s21, s25
s_add_u32 s21, s21, 61
s_cmp_lt_u32 s25, 3
s_cselect_b32 s17, 99, 0
s_add_u32 s21, s21, s17
s_lshl1_add_u32 s27, s27, s25
s_sub_u32 s27, s27, 6
s_cmp_eq_u32 s34, 1
s_cselect_b32 s21, s27, s21
s_lshl_b32 s17, s16, 12
v_and_b32 v60, 15, v0
v_lshrrev_b32 v61, 4, v0
v_lshrrev_b32 v62, 1, v60
v_xor_b32 v62, v62, v61
v_lshlrev_b32 v62, 4, v62
v_lshl_add_u32 v62, v60, 7, v62
v_add_u32 v2, s17, v62
v_xor_b32 v3, 64, v2
v_bfe_u32 v60, v0, 2, 2
v_lshl_add_u32 v62, v61, 3, v60
v_and_b32 v61, 1, v61
v_lshlrev_b32 v61, 5, v61
v_and_b32 v63, 3, v0
v_lshl_add_u32 v61, v63, 3, v61
v_lshl_add_u32 v12, v62, 6, v61
v_add_u32 v12, 32768, v12
v_xor_b32 v13, 32, v12
v_lshl_add_u32 v62, v62, 8, v61
v_lshl_add_u32 v62, v60, 6, v62
v_add_u32 v62, 16384, v62

v_xor_b32 v4, 0, v62
v_xor_b32 v5, 32, v62
v_xor_b32 v6, 64, v62
v_xor_b32 v7, 96, v62
v_xor_b32 v8, 128, v62
v_xor_b32 v9, 160, v62
v_xor_b32 v10, 192, v62
v_xor_b32 v11, 224, v62
v_and_b32 v60, 15, v0
s_lshl_b32 s17, s16, 8
s_add_u32 s17, s17, 160768
v_lshl_add_u32 v240, v60, 3, s17
v_lshlrev_b32 v241, 3, v0
v_add_u32 v241, 155648, v241
v_mov_b32 v242, 162816
v_mov_b32 v243, 1
v_lshrrev_b32 v60, 4, v0
v_cmp_eq_u32 s[66:67], 0, v60
v_cmp_eq_u32 s[68:69], 1, v60
v_mov_b32 v194, 0
v_mov_b32 v195, 0
v_mov_b32 v198, 0
v_mov_b32 v199, 0
v_mov_b32 v202, 0
v_mov_b32 v203, 0
v_mov_b32 v206, 0
v_mov_b32 v207, 0
v_mov_b32 v210, 0
v_mov_b32 v211, 0
v_mov_b32 v214, 0
v_mov_b32 v215, 0
v_mov_b32 v218, 0
v_mov_b32 v219, 0
v_mov_b32 v222, 0
v_mov_b32 v223, 0
v_mov_b32 v226, 0
v_mov_b32 v227, 0
v_mov_b32 v230, 0
v_mov_b32 v231, 0
v_mov_b32 v234, 0
v_mov_b32 v235, 0
v_mov_b32 v238, 0
v_mov_b32 v239, 0
v_mov_b32 v112, 0
v_mov_b32 v113, 0
v_mov_b32 v114, 0
v_mov_b32 v115, 0
v_mov_b32 v116, 0
v_mov_b32 v117, 0
v_mov_b32 v118, 0
v_mov_b32 v119, 0
v_mov_b32 v120, 0
v_mov_b32 v121, 0
v_mov_b32 v122, 0
v_mov_b32 v123, 0
v_mov_b32 v124, 0
v_mov_b32 v125, 0
v_mov_b32 v126, 0
v_mov_b32 v127, 0
v_mov_b32 v128, 0
v_mov_b32 v129, 0
v_mov_b32 v130, 0
v_mov_b32 v131, 0
v_mov_b32 v132, 0
v_mov_b32 v133, 0
v_mov_b32 v134, 0
v_mov_b32 v135, 0
v_mov_b32 v136, 0
v_mov_b32 v137, 0
v_mov_b32 v138, 0
v_mov_b32 v139, 0
v_mov_b32 v140, 0
v_mov_b32 v141, 0
v_mov_b32 v142, 0
v_mov_b32 v143, 0
v_mov_b32 v144, 0
v_mov_b32 v145, 0
v_mov_b32 v146, 0
v_mov_b32 v147, 0
v_mov_b32 v148, 0
v_mov_b32 v149, 0
v_mov_b32 v150, 0
v_mov_b32 v151, 0
v_mov_b32 v152, 0
v_mov_b32 v153, 0
v_mov_b32 v154, 0
v_mov_b32 v155, 0
v_mov_b32 v156, 0
v_mov_b32 v157, 0
v_mov_b32 v158, 0
v_mov_b32 v159, 0
v_mov_b32 v160, 0
v_mov_b32 v161, 0
v_mov_b32 v162, 0
v_mov_b32 v163, 0
v_mov_b32 v164, 0
v_mov_b32 v165, 0
v_mov_b32 v166, 0
v_mov_b32 v167, 0
v_mov_b32 v168, 0
v_mov_b32 v169, 0
v_mov_b32 v170, 0
v_mov_b32 v171, 0
v_mov_b32 v172, 0
v_mov_b32 v173, 0
v_mov_b32 v174, 0
v_mov_b32 v175, 0
v_mov_b32 v176, 0
v_mov_b32 v177, 0
v_mov_b32 v178, 0
v_mov_b32 v179, 0
v_mov_b32 v180, 0
v_mov_b32 v181, 0
v_mov_b32 v182, 0
v_mov_b32 v183, 0
v_mov_b32 v184, 0
v_mov_b32 v185, 0
v_mov_b32 v186, 0
v_mov_b32 v187, 0
v_mov_b32 v188, 0
v_mov_b32 v189, 0
v_mov_b32 v190, 0
v_mov_b32 v191, 0
s_waitcnt lgkmcnt(0)
s_mul_i32 s14, s14, 0x9E3779B1
s_add_u32 s14, s14, 0x85EBCA6B
s_barrier
s_waitcnt vmcnt(0)
v_mov_b32 v40, 0x3f803f80
v_mov_b32 v41, 0xbf803f80
v_mov_b32 v56, 0
v_mov_b32 v57, 0
v_mov_b32 v58, 0
v_mov_b32 v59, 0
v_mov_b32 v60, 0
v_mov_b32 v61, 0
v_dot2c_f32_bf16 v56, v20, v40
v_dot2c_f32_bf16 v57, v20, v41
v_dot2c_f32_bf16 v58, v20, v20
v_dot2c_f32_bf16 v59, v21, v40
v_dot2c_f32_bf16 v60, v21, v41
v_dot2c_f32_bf16 v61, v21, v21
v_dot2c_f32_bf16 v56, v22, v40
v_dot2c_f32_bf16 v57, v22, v41
v_dot2c_f32_bf16 v58, v22, v22
v_dot2c_f32_bf16 v59, v23, v40
v_dot2c_f32_bf16 v60, v23, v41
v_dot2c_f32_bf16 v61, v23, v23
v_dot2c_f32_bf16 v56, v24, v40
v_dot2c_f32_bf16 v57, v24, v41
v_dot2c_f32_bf16 v58, v24, v24
v_dot2c_f32_bf16 v59, v25, v40
v_dot2c_f32_bf16 v60, v25, v41
v_dot2c_f32_bf16 v61, v25, v25
v_dot2c_f32_bf16 v56, v26, v40
v_dot2c_f32_bf16 v57, v26, v41
v_dot2c_f32_bf16 v58, v26, v26
v_dot2c_f32_bf16 v59, v27, v40
v_dot2c_f32_bf16 v60, v27, v41
v_dot2c_f32_bf16 v61, v27, v27
s_mov_b32 exec_lo, 0xffff
s_mov_b32 exec_hi, 0xffff
v_dot2c_f32_bf16 v56, v28, v40
v_dot2c_f32_bf16 v57, v28, v41
v_dot2c_f32_bf16 v58, v28, v28
v_dot2c_f32_bf16 v59, v29, v40
v_dot2c_f32_bf16 v60, v29, v41
v_dot2c_f32_bf16 v61, v29, v29
v_dot2c_f32_bf16 v56, v30, v40
v_dot2c_f32_bf16 v57, v30, v41
v_dot2c_f32_bf16 v58, v30, v30
v_dot2c_f32_bf16 v59, v31, v40
v_dot2c_f32_bf16 v60, v31, v41
v_dot2c_f32_bf16 v61, v31, v31
s_mov_b64 exec, -1
s_nop 2
v_add_f32 v56, v56, v59
v_add_f32 v57, v57, v60
v_add_f32 v59, v58, v61
v_add_f32_dpp v56, v56, v56 quad_perm:[1,0,3,2] row_mask:0xf bank_mask:0xf
v_add_f32_dpp v57, v57, v57 quad_perm:[1,0,3,2] row_mask:0xf bank_mask:0xf
v_add_f32_dpp v59, v59, v59 quad_perm:[1,0,3,2] row_mask:0xf bank_mask:0xf
v_add_f32_dpp v56, v56, v56 quad_perm:[2,3,0,1] row_mask:0xf bank_mask:0xf
v_add_f32_dpp v57, v57, v57 quad_perm:[2,3,0,1] row_mask:0xf bank_mask:0xf
v_add_f32_dpp v59, v59, v59 quad_perm:[2,3,0,1] row_mask:0xf bank_mask:0xf
v_add_f32_dpp v56, v56, v56 row_half_mirror row_mask:0xf bank_mask:0xf
v_add_f32_dpp v57, v57, v57 row_half_mirror row_mask:0xf bank_mask:0xf
v_add_f32_dpp v59, v59, v59 row_half_mirror row_mask:0xf bank_mask:0xf
v_add_f32_dpp v56, v56, v56 row_mirror row_mask:0xf bank_mask:0xf
v_add_f32_dpp v57, v57, v57 row_mirror row_mask:0xf bank_mask:0xf
v_add_f32_dpp v59, v59, v59 row_mirror row_mask:0xf bank_mask:0xf
v_mov_b32 v60, v56
v_mov_b32 v61, v57
v_mov_b32 v62, v59
s_nop 1
v_permlane16_swap_b32 v56, v60
v_permlane16_swap_b32 v57, v61
v_permlane16_swap_b32 v59, v62
v_add_f32 v56, v56, v60
v_add_f32 v57, v57, v61
v_add_f32 v59, v59, v62
v_mul_f32 v58, 0x3acccccd, v56
v_fma_f32 v59, -v58, v56, v59
v_max_f32 v59, 0, v59
v_mul_f32 v59, 0x3acccccd, v59
v_cvt_pk_bf16_f32 v59, v59, v59
v_lshlrev_b32 v59, 16, v59
v_add_f32 v59, 0x3727c5ac, v59
v_cvt_pk_bf16_f32 v59, v59, v59
v_lshlrev_b32 v59, 16, v59
v_sqrt_f32 v59, v59
v_mov_b32 v35, s14
v_cvt_pk_bf16_f32 v32, -v58, v59
v_and_b32 v59, 0xffff0000, v32
v_rcp_f32 v33, v59
s_lshl_b32 s17, s16, 1
v_mul_f32 v34, v33, v57
v_lshrrev_b32 v36, 5, v0
v_add_u32 v36, s17, v36
v_lshlrev_b32 v37, 4, v36
v_add_u32 v37, 163072, v37
s_mov_b32 exec_lo, 1
s_mov_b32 exec_hi, 1
ds_write_b128 v37, v[32:35]
s_mov_b64 exec, -1

s_waitcnt lgkmcnt(0)
s_cmp_eq_u32 s34, 1
s_cbranch_scc1 L_gD
s_cmp_eq_u32 s33, 0
s_cbranch_scc1 L_g4
L_g5:
s_mov_b32 s18, 0
s_mov_b32 s17, 73728
s_barrier
ds_read_b128 v[16:19], v2 offset:0
ds_read_b128 v[20:23], v2 offset:2048
ds_read_b64_tr_b16 v[24:25], v4 offset:0
ds_read_b64_tr_b16 v[26:27], v4 offset:1024
ds_read_b64_tr_b16 v[28:29], v5 offset:0
ds_read_b64_tr_b16 v[30:31], v5 offset:1024
ds_read_b64_tr_b16 v[32:33], v6 offset:0
ds_read_b64_tr_b16 v[34:35], v6 offset:1024
ds_read_b64_tr_b16 v[36:37], v7 offset:0
ds_read_b64_tr_b16 v[38:39], v7 offset:1024
ds_read_b64_tr_b16 v[40:41], v8 offset:0
ds_read_b64_tr_b16 v[42:43], v8 offset:1024
ds_read_b64_tr_b16 v[44:45], v9 offset:0
ds_read_b64_tr_b16 v[46:47], v9 offset:1024
ds_read_b64_tr_b16 v[48:49], v10 offset:0
ds_read_b64_tr_b16 v[50:51], v10 offset:1024
ds_read_b64_tr_b16 v[52:53], v11 offset:0
ds_read_b64_tr_b16 v[54:55], v11 offset:1024
ds_read_b64_tr_b16 v[56:57], v12 offset:0
ds_read_b64_tr_b16 v[58:59], v12 offset:256
ds_read_b64_tr_b16 v[60:61], v13 offset:0
ds_read_b64_tr_b16 v[62:63], v13 offset:256
.p2align 3
L_g5_loop:
s_waitcnt lgkmcnt(0)
s_nop 0
v_mfma_f32_16x16x32_bf16 v[112:115], v[24:27], v[16:19], v[112:115]
ds_read_b128 v[64:67], v3 offset:0
ds_read_b128 v[68:71], v3 offset:2048
v_mfma_f32_16x16x32_bf16 v[116:119], v[24:27], v[20:23], v[116:119]
ds_read_b64_tr_b16 v[72:73], v4 offset:8192
ds_read_b64_tr_b16 v[74:75], v4 offset:9216
v_mfma_f32_16x16x32_bf16 v[120:123], v[28:31], v[16:19], v[120:123]
ds_read_b64_tr_b16 v[76:77], v5 offset:8192
ds_read_b64_tr_b16 v[78:79], v5 offset:9216
v_mfma_f32_16x16x32_bf16 v[124:127], v[28:31], v[20:23], v[124:127]
ds_read_b64_tr_b16 v[80:81], v6 offset:8192
ds_read_b64_tr_b16 v[82:83], v6 offset:9216
v_mfma_f32_16x16x32_bf16 v[128:131], v[32:35], v[16:19], v[128:131]
ds_read_b64_tr_b16 v[84:85], v7 offset:8192
ds_read_b64_tr_b16 v[86:87], v7 offset:9216
v_mfma_f32_16x16x32_bf16 v[132:135], v[32:35], v[20:23], v[132:135]
ds_read_b64_tr_b16 v[88:89], v8 offset:8192
ds_read_b64_tr_b16 v[90:91], v8 offset:9216
v_mfma_f32_16x16x32_bf16 v[136:139], v[36:39], v[16:19], v[136:139]
ds_read_b64_tr_b16 v[92:93], v9 offset:8192
v_mfma_f32_16x16x32_bf16 v[140:143], v[36:39], v[20:23], v[140:143]
ds_read_b64_tr_b16 v[94:95], v9 offset:9216
v_mfma_f32_16x16x32_bf16 v[144:147], v[40:43], v[16:19], v[144:147]
ds_read_b64_tr_b16 v[96:97], v10 offset:8192
v_mfma_f32_16x16x32_bf16 v[148:151], v[40:43], v[20:23], v[148:151]
ds_read_b64_tr_b16 v[98:99], v10 offset:9216
v_mfma_f32_16x16x32_bf16 v[152:155], v[44:47], v[16:19], v[152:155]
ds_read_b64_tr_b16 v[100:101], v11 offset:8192
v_mfma_f32_16x16x32_bf16 v[156:159], v[44:47], v[20:23], v[156:159]
ds_read_b64_tr_b16 v[102:103], v11 offset:9216
v_mfma_f32_16x16x32_bf16 v[160:163], v[48:51], v[16:19], v[160:163]
ds_read_b64_tr_b16 v[104:105], v12 offset:2048
v_mfma_f32_16x16x32_bf16 v[164:167], v[48:51], v[20:23], v[164:167]
ds_read_b64_tr_b16 v[106:107], v12 offset:2304
v_mfma_f32_16x16x32_bf16 v[168:171], v[52:55], v[16:19], v[168:171]
ds_read_b64_tr_b16 v[108:109], v13 offset:2048
v_mfma_f32_16x16x32_bf16 v[172:175], v[52:55], v[20:23], v[172:175]
ds_read_b64_tr_b16 v[110:111], v13 offset:2304
v_mfma_f32_16x16x32_bf16 v[176:179], v[56:59], v[16:19], v[176:179]
v_mfma_f32_16x16x32_bf16 v[180:183], v[56:59], v[20:23], v[180:183]
v_mfma_f32_16x16x32_bf16 v[184:187], v[60:63], v[16:19], v[184:187]
v_mfma_f32_16x16x32_bf16 v[188:191], v[60:63], v[20:23], v[188:191]
s_waitcnt lgkmcnt(0)
s_nop 0
v_mfma_f32_16x16x32_bf16 v[112:115], v[72:75], v[64:67], v[112:115]
s_add_u32 s18, s18, 1
s_cmp_eq_u32 s18, 5
v_mfma_f32_16x16x32_bf16 v[116:119], v[72:75], v[68:71], v[116:119]
s_barrier
s_nop 0
v_mfma_f32_16x16x32_bf16 v[120:123], v[76:79], v[64:67], v[120:123]
ds_read_b128 v[16:19], v2 offset:36864
ds_read_b128 v[20:23], v2 offset:38912
v_mfma_f32_16x16x32_bf16 v[124:127], v[76:79], v[68:71], v[124:127]
ds_read_b64_tr_b16 v[24:25], v4 offset:36864
ds_read_b64_tr_b16 v[26:27], v4 offset:37888
v_mfma_f32_16x16x32_bf16 v[128:131], v[80:83], v[64:67], v[128:131]
ds_read_b64_tr_b16 v[28:29], v5 offset:36864
ds_read_b64_tr_b16 v[30:31], v5 offset:37888
v_mfma_f32_16x16x32_bf16 v[132:135], v[80:83], v[68:71], v[132:135]
ds_read_b64_tr_b16 v[32:33], v6 offset:36864
ds_read_b64_tr_b16 v[34:35], v6 offset:37888
v_mfma_f32_16x16x32_bf16 v[136:139], v[84:87], v[64:67], v[136:139]
ds_read_b64_tr_b16 v[36:37], v7 offset:36864
ds_read_b64_tr_b16 v[38:39], v7 offset:37888
v_mfma_f32_16x16x32_bf16 v[140:143], v[84:87], v[68:71], v[140:143]
ds_read_b64_tr_b16 v[40:41], v8 offset:36864
ds_read_b64_tr_b16 v[42:43], v8 offset:37888
v_mfma_f32_16x16x32_bf16 v[144:147], v[88:91], v[64:67], v[144:147]
ds_read_b64_tr_b16 v[44:45], v9 offset:36864
ds_read_b64_tr_b16 v[46:47], v9 offset:37888
v_mfma_f32_16x16x32_bf16 v[148:151], v[88:91], v[68:71], v[148:151]
ds_read_b64_tr_b16 v[48:49], v10 offset:36864
ds_read_b64_tr_b16 v[50:51], v10 offset:37888
v_mfma_f32_16x16x32_bf16 v[152:155], v[92:95], v[64:67], v[152:155]
ds_read_b64_tr_b16 v[52:53], v11 offset:36864
v_mfma_f32_16x16x32_bf16 v[156:159], v[92:95], v[68:71], v[156:159]
ds_read_b64_tr_b16 v[54:55], v11 offset:37888
v_mfma_f32_16x16x32_bf16 v[160:163], v[96:99], v[64:67], v[160:163]
ds_read_b64_tr_b16 v[56:57], v12 offset:36864
v_mfma_f32_16x16x32_bf16 v[164:167], v[96:99], v[68:71], v[164:167]
ds_read_b64_tr_b16 v[58:59], v12 offset:37120
v_mfma_f32_16x16x32_bf16 v[168:171], v[100:103], v[64:67], v[168:171]
ds_read_b64_tr_b16 v[60:61], v13 offset:36864
v_mfma_f32_16x16x32_bf16 v[172:175], v[100:103], v[68:71], v[172:175]
ds_read_b64_tr_b16 v[62:63], v13 offset:37120
v_mfma_f32_16x16x32_bf16 v[176:179], v[104:107], v[64:67], v[176:179]
v_mfma_f32_16x16x32_bf16 v[180:183], v[104:107], v[68:71], v[180:183]
v_mfma_f32_16x16x32_bf16 v[184:187], v[108:111], v[64:67], v[184:187]
v_mfma_f32_16x16x32_bf16 v[188:191], v[108:111], v[68:71], v[188:191]
s_waitcnt lgkmcnt(0)
s_nop 0
v_mfma_f32_16x16x32_bf16 v[112:115], v[24:27], v[16:19], v[112:115]
ds_read_b128 v[64:67], v3 offset:36864
ds_read_b128 v[68:71], v3 offset:38912
v_mfma_f32_16x16x32_bf16 v[116:119], v[24:27], v[20:23], v[116:119]
ds_read_b64_tr_b16 v[72:73], v4 offset:45056
ds_read_b64_tr_b16 v[74:75], v4 offset:46080
v_mfma_f32_16x16x32_bf16 v[120:123], v[28:31], v[16:19], v[120:123]
ds_read_b64_tr_b16 v[76:77], v5 offset:45056
ds_read_b64_tr_b16 v[78:79], v5 offset:46080
v_mfma_f32_16x16x32_bf16 v[124:127], v[28:31], v[20:23], v[124:127]
ds_read_b64_tr_b16 v[80:81], v6 offset:45056
ds_read_b64_tr_b16 v[82:83], v6 offset:46080
v_mfma_f32_16x16x32_bf16 v[128:131], v[32:35], v[16:19], v[128:131]
ds_read_b64_tr_b16 v[84:85], v7 offset:45056
ds_read_b64_tr_b16 v[86:87], v7 offset:46080
v_mfma_f32_16x16x32_bf16 v[132:135], v[32:35], v[20:23], v[132:135]
ds_read_b64_tr_b16 v[88:89], v8 offset:45056
ds_read_b64_tr_b16 v[90:91], v8 offset:46080
v_mfma_f32_16x16x32_bf16 v[136:139], v[36:39], v[16:19], v[136:139]
ds_read_b64_tr_b16 v[92:93], v9 offset:45056
v_mfma_f32_16x16x32_bf16 v[140:143], v[36:39], v[20:23], v[140:143]
ds_read_b64_tr_b16 v[94:95], v9 offset:46080
v_mfma_f32_16x16x32_bf16 v[144:147], v[40:43], v[16:19], v[144:147]
ds_read_b64_tr_b16 v[96:97], v10 offset:45056
v_mfma_f32_16x16x32_bf16 v[148:151], v[40:43], v[20:23], v[148:151]
ds_read_b64_tr_b16 v[98:99], v10 offset:46080
v_mfma_f32_16x16x32_bf16 v[152:155], v[44:47], v[16:19], v[152:155]
ds_read_b64_tr_b16 v[100:101], v11 offset:45056
v_mfma_f32_16x16x32_bf16 v[156:159], v[44:47], v[20:23], v[156:159]
ds_read_b64_tr_b16 v[102:103], v11 offset:46080
v_mfma_f32_16x16x32_bf16 v[160:163], v[48:51], v[16:19], v[160:163]
ds_read_b64_tr_b16 v[104:105], v12 offset:38912
v_mfma_f32_16x16x32_bf16 v[164:167], v[48:51], v[20:23], v[164:167]
ds_read_b64_tr_b16 v[106:107], v12 offset:39168
v_mfma_f32_16x16x32_bf16 v[168:171], v[52:55], v[16:19], v[168:171]
ds_read_b64_tr_b16 v[108:109], v13 offset:38912
v_mfma_f32_16x16x32_bf16 v[172:175], v[52:55], v[20:23], v[172:175]
ds_read_b64_tr_b16 v[110:111], v13 offset:39168
v_mfma_f32_16x16x32_bf16 v[176:179], v[56:59], v[16:19], v[176:179]
v_add_u32 v2, s17, v2
v_add_u32 v3, s17, v3
v_add_u32 v4, s17, v4
v_mfma_f32_16x16x32_bf16 v[180:183], v[56:59], v[20:23], v[180:183]
v_add_u32 v5, s17, v5
v_add_u32 v6, s17, v6
v_add_u32 v7, s17, v7
v_mfma_f32_16x16x32_bf16 v[184:187], v[60:63], v[16:19], v[184:187]
v_add_u32 v8, s17, v8
v_add_u32 v9, s17, v9
v_add_u32 v10, s17, v10
v_mfma_f32_16x16x32_bf16 v[188:191], v[60:63], v[20:23], v[188:191]
v_add_u32 v11, s17, v11
v_add_u32 v12, s17, v12
v_add_u32 v13, s17, v13
s_waitcnt lgkmcnt(0)
s_nop 0
v_mfma_f32_16x16x32_bf16 v[112:115], v[72:75], v[64:67], v[112:115]
s_cbranch_scc1 L_g5_fin
s_sub_u32 s17, 0, s17
v_mfma_f32_16x16x32_bf16 v[116:119], v[72:75], v[68:71], v[116:119]
s_barrier
s_nop 0
v_mfma_f32_16x16x32_bf16 v[120:123], v[76:79], v[64:67], v[120:123]
ds_read_b128 v[16:19], v2 offset:0
ds_read_b128 v[20:23], v2 offset:2048
v_mfma_f32_16x16x32_bf16 v[124:127], v[76:79], v[68:71], v[124:127]
ds_read_b64_tr_b16 v[24:25], v4 offset:0
ds_read_b64_tr_b16 v[26:27], v4 offset:1024
v_mfma_f32_16x16x32_bf16 v[128:131], v[80:83], v[64:67], v[128:131]
ds_read_b64_tr_b16 v[28:29], v5 offset:0
ds_read_b64_tr_b16 v[30:31], v5 offset:1024
v_mfma_f32_16x16x32_bf16 v[132:135], v[80:83], v[68:71], v[132:135]
ds_read_b64_tr_b16 v[32:33], v6 offset:0
ds_read_b64_tr_b16 v[34:35], v6 offset:1024
v_mfma_f32_16x16x32_bf16 v[136:139], v[84:87], v[64:67], v[136:139]
ds_read_b64_tr_b16 v[36:37], v7 offset:0
ds_read_b64_tr_b16 v[38:39], v7 offset:1024
v_mfma_f32_16x16x32_bf16 v[140:143], v[84:87], v[68:71], v[140:143]
ds_read_b64_tr_b16 v[40:41], v8 offset:0
ds_read_b64_tr_b16 v[42:43], v8 offset:1024
v_mfma_f32_16x16x32_bf16 v[144:147], v[88:91], v[64:67], v[144:147]
ds_read_b64_tr_b16 v[44:45], v9 offset:0
ds_read_b64_tr_b16 v[46:47], v9 offset:1024
v_mfma_f32_16x16x32_bf16 v[148:151], v[88:91], v[68:71], v[148:151]
ds_read_b64_tr_b16 v[48:49], v10 offset:0
ds_read_b64_tr_b16 v[50:51], v10 offset:1024
v_mfma_f32_16x16x32_bf16 v[152:155], v[92:95], v[64:67], v[152:155]
ds_read_b64_tr_b16 v[52:53], v11 offset:0
v_mfma_f32_16x16x32_bf16 v[156:159], v[92:95], v[68:71], v[156:159]
ds_read_b64_tr_b16 v[54:55], v11 offset:1024
v_mfma_f32_16x16x32_bf16 v[160:163], v[96:99], v[64:67], v[160:163]
ds_read_b64_tr_b16 v[56:57], v12 offset:0
v_mfma_f32_16x16x32_bf16 v[164:167], v[96:99], v[68:71], v[164:167]
ds_read_b64_tr_b16 v[58:59], v12 offset:256
v_mfma_f32_16x16x32_bf16 v[168:171], v[100:103], v[64:67], v[168:171]
ds_read_b64_tr_b16 v[60:61], v13 offset:0
v_mfma_f32_16x16x32_bf16 v[172:175], v[100:103], v[68:71], v[172:175]
ds_read_b64_tr_b16 v[62:63], v13 offset:256
v_mfma_f32_16x16x32_bf16 v[176:179], v[104:107], v[64:67], v[176:179]
v_mfma_f32_16x16x32_bf16 v[180:183], v[104:107], v[68:71], v[180:183]
v_mfma_f32_16x16x32_bf16 v[184:187], v[108:111], v[64:67], v[184:187]
v_mfma_f32_16x16x32_bf16 v[188:191], v[108:111], v[68:71], v[188:191]
s_branch L_g5_loop
L_g5_fin:
v_mfma_f32_16x16x32_bf16 v[116:119], v[72:75], v[68:71], v[116:119]
s_mov_b64 exec, 1
ds_add_u32 v242, v243 offset:76
s_mov_b64 exec, -1
v_mfma_f32_16x16x32_bf16 v[120:123], v[76:79], v[64:67], v[120:123]
ds_read_b64 v[248:249], v240
v_mfma_f32_16x16x32_bf16 v[124:127], v[76:79], v[68:71], v[124:127]
ds_read_b64 v[250:251], v240 offset:128
v_mfma_f32_16x16x32_bf16 v[128:131], v[80:83], v[64:67], v[128:131]
ds_read_b64 v[192:193], v241 offset:0
v_mfma_f32_16x16x32_bf16 v[132:135], v[80:83], v[68:71], v[132:135]
ds_read_b64 v[196:197], v241 offset:512
v_mfma_f32_16x16x32_bf16 v[136:139], v[84:87], v[64:67], v[136:139]
ds_read_b64 v[200:201], v241 offset:1024
v_mfma_f32_16x16x32_bf16 v[140:143], v[84:87], v[68:71], v[140:143]
ds_read_b64 v[204:205], v241 offset:1536
v_mfma_f32_16x16x32_bf16 v[144:147], v[88:91], v[64:67], v[144:147]
ds_read_b64 v[208:209], v241 offset:2048
v_mfma_f32_16x16x32_bf16 v[148:151], v[88:91], v[68:71], v[148:151]
ds_read_b64 v[212:213], v241 offset:2560
v_mfma_f32_16x16x32_bf16 v[152:155], v[92:95], v[64:67], v[152:155]
ds_read_b64 v[216:217], v241 offset:3072
v_mfma_f32_16x16x32_bf16 v[156:159], v[92:95], v[68:71], v[156:159]
ds_read_b64 v[220:221], v241 offset:3584
v_mfma_f32_16x16x32_bf16 v[160:163], v[96:99], v[64:67], v[160:163]
ds_read_b64 v[224:225], v241 offset:4096
v_mfma_f32_16x16x32_bf16 v[164:167], v[96:99], v[68:71], v[164:167]
ds_read_b64 v[228:229], v241 offset:4608
v_mfma_f32_16x16x32_bf16 v[168:171], v[100:103], v[64:67], v[168:171]
s_waitcnt lgkmcnt(10)
v_mfma_f32_16x16x32_bf16 v[172:175], v[100:103], v[68:71], v[172:175]
v_cndmask_b32 v233, 0, v248, s[66:67]
v_mfma_f32_16x16x32_bf16 v[176:179], v[104:107], v[64:67], v[176:179]
v_cndmask_b32 v232, v233, v249, s[68:69]
v_mfma_f32_16x16x32_bf16 v[180:183], v[104:107], v[68:71], v[180:183]
v_cndmask_b32 v237, 0, v250, s[66:67]
v_mfma_f32_16x16x32_bf16 v[184:187], v[108:111], v[64:67], v[184:187]
v_cndmask_b32 v236, v237, v251, s[68:69]
v_mfma_f32_16x16x32_bf16 v[188:191], v[108:111], v[68:71], v[188:191]
s_waitcnt lgkmcnt(0)
v_mfma_f32_16x16x32_bf16 v[112:115], v[192:195], v[232:235], v[112:115]
v_mfma_f32_16x16x32_bf16 v[116:119], v[192:195], v[236:239], v[116:119]
v_mfma_f32_16x16x32_bf16 v[120:123], v[196:199], v[232:235], v[120:123]
v_mfma_f32_16x16x32_bf16 v[124:127], v[196:199], v[236:239], v[124:127]
v_mfma_f32_16x16x32_bf16 v[128:131], v[200:203], v[232:235], v[128:131]
v_mfma_f32_16x16x32_bf16 v[132:135], v[200:203], v[236:239], v[132:135]
v_mfma_f32_16x16x32_bf16 v[136:139], v[204:207], v[232:235], v[136:139]
v_mfma_f32_16x16x32_bf16 v[140:143], v[204:207], v[236:239], v[140:143]
v_mfma_f32_16x16x32_bf16 v[144:147], v[208:211], v[232:235], v[144:147]
v_mfma_f32_16x16x32_bf16 v[148:151], v[208:211], v[236:239], v[148:151]
v_mfma_f32_16x16x32_bf16 v[152:155], v[212:215], v[232:235], v[152:155]
v_mfma_f32_16x16x32_bf16 v[156:159], v[212:215], v[236:239], v[156:159]
v_mfma_f32_16x16x32_bf16 v[160:163], v[216:219], v[232:235], v[160:163]
v_mfma_f32_16x16x32_bf16 v[164:167], v[216:219], v[236:239], v[164:167]
v_mfma_f32_16x16x32_bf16 v[168:171], v[220:223], v[232:235], v[168:171]
v_mfma_f32_16x16x32_bf16 v[172:175], v[220:223], v[236:239], v[172:175]
v_mfma_f32_16x16x32_bf16 v[176:179], v[224:227], v[232:235], v[176:179]
v_mfma_f32_16x16x32_bf16 v[180:183], v[224:227], v[236:239], v[180:183]
v_mfma_f32_16x16x32_bf16 v[184:187], v[228:231], v[232:235], v[184:187]
v_mfma_f32_16x16x32_bf16 v[188:191], v[228:231], v[236:239], v[188:191]
v_lshlrev_b32 v11, 4, v0
s_lshl_b32 s17, s26, 2
s_add_u32 s17, s17, s16
s_mul_i32 s17, s17, 110592
s_add_u32 s17, s17, 4194304
s_cmp_lt_u32 s28, 42
s_cselect_b32 s27, 12, -30
s_cmp_lt_u32 s28, 32
s_cselect_b32 s27, -20, s27
s_cmp_lt_u32 s28, 20
s_cselect_b32 s27, 24, s27
s_lshl_b32 s27, s27, 11
s_add_u32 s17, s17, s27
s_lshl_b32 s18, s30, 11
s_add_u32 s18, s18, s17
s_lshl_b32 s19, s28, 11
s_add_u32 s17, s17, s19
s_add_u32 s19, s17, 4096
.p2align 3
v_max_f32 v84, 0, v112
v_max_f32 v85, 0, v113
v_max_f32 v86, 0, v114
v_max_f32 v87, 0, v115
v_pk_mul_f32 v[84:85], v[84:85], v[112:113]
v_max_f32 v88, 0, v120
v_max_f32 v89, 0, v121
v_pk_mul_f32 v[86:87], v[86:87], v[114:115]
v_cvt_pk_bf16_f32 v68, v84, v85
v_max_f32 v90, 0, v122
v_max_f32 v91, 0, v123
v_pk_mul_f32 v[88:89], v[88:89], v[120:121]
v_cvt_pk_bf16_f32 v69, v86, v87
v_max_f32 v84, 0, v116
v_max_f32 v85, 0, v117
v_pk_mul_f32 v[90:91], v[90:91], v[122:123]
v_cvt_pk_bf16_f32 v70, v88, v89
v_max_f32 v86, 0, v118
v_max_f32 v87, 0, v119
v_pk_mul_f32 v[84:85], v[84:85], v[116:117]
v_cvt_pk_bf16_f32 v71, v90, v91
v_max_f32 v88, 0, v124
v_max_f32 v89, 0, v125
v_pk_mul_f32 v[86:87], v[86:87], v[118:119]
v_cvt_pk_bf16_f32 v72, v84, v85
v_max_f32 v90, 0, v126
v_max_f32 v91, 0, v127
v_pk_mul_f32 v[88:89], v[88:89], v[124:125]
v_cvt_pk_bf16_f32 v73, v86, v87
v_pk_mul_f32 v[90:91], v[90:91], v[126:127]
v_cvt_pk_bf16_f32 v74, v88, v89
v_cvt_pk_bf16_f32 v75, v90, v91
buffer_store_dwordx4 v[68:71], v11, s[44:47], s17 offen offset:0 sc1
buffer_store_dwordx4 v[72:75], v11, s[44:47], s17 offen offset:1024 sc1
v_max_f32 v84, 0, v128
v_max_f32 v85, 0, v129
v_max_f32 v86, 0, v130
v_max_f32 v87, 0, v131
v_pk_mul_f32 v[84:85], v[84:85], v[128:129]
v_max_f32 v88, 0, v136
v_max_f32 v89, 0, v137
v_pk_mul_f32 v[86:87], v[86:87], v[130:131]
v_cvt_pk_bf16_f32 v76, v84, v85
v_max_f32 v90, 0, v138
v_max_f32 v91, 0, v139
v_pk_mul_f32 v[88:89], v[88:89], v[136:137]
v_cvt_pk_bf16_f32 v77, v86, v87
v_max_f32 v84, 0, v132
v_max_f32 v85, 0, v133
v_pk_mul_f32 v[90:91], v[90:91], v[138:139]
v_cvt_pk_bf16_f32 v78, v88, v89
v_max_f32 v86, 0, v134
v_max_f32 v87, 0, v135
v_pk_mul_f32 v[84:85], v[84:85], v[132:133]
v_cvt_pk_bf16_f32 v79, v90, v91
v_max_f32 v88, 0, v140
v_max_f32 v89, 0, v141
v_pk_mul_f32 v[86:87], v[86:87], v[134:135]
v_cvt_pk_bf16_f32 v80, v84, v85
v_max_f32 v90, 0, v142
v_max_f32 v91, 0, v143
v_pk_mul_f32 v[88:89], v[88:89], v[140:141]
v_cvt_pk_bf16_f32 v81, v86, v87
v_pk_mul_f32 v[90:91], v[90:91], v[142:143]
v_cvt_pk_bf16_f32 v82, v88, v89
v_cvt_pk_bf16_f32 v83, v90, v91
buffer_store_dwordx4 v[76:79], v11, s[44:47], s17 offen offset:2048 sc1
buffer_store_dwordx4 v[80:83], v11, s[44:47], s17 offen offset:3072 sc1
v_max_f32 v84, 0, v144
v_max_f32 v85, 0, v145
v_max_f32 v86, 0, v146
v_max_f32 v87, 0, v147
v_pk_mul_f32 v[84:85], v[84:85], v[144:145]
v_max_f32 v88, 0, v152
v_max_f32 v89, 0, v153
v_pk_mul_f32 v[86:87], v[86:87], v[146:147]
v_cvt_pk_bf16_f32 v68, v84, v85
v_max_f32 v90, 0, v154
v_max_f32 v91, 0, v155
v_pk_mul_f32 v[88:89], v[88:89], v[152:153]
v_cvt_pk_bf16_f32 v69, v86, v87
v_max_f32 v84, 0, v148
v_max_f32 v85, 0, v149
v_pk_mul_f32 v[90:91], v[90:91], v[154:155]
v_cvt_pk_bf16_f32 v70, v88, v89
v_max_f32 v86, 0, v150
v_max_f32 v87, 0, v151
v_pk_mul_f32 v[84:85], v[84:85], v[148:149]
v_cvt_pk_bf16_f32 v71, v90, v91
v_max_f32 v88, 0, v156
v_max_f32 v89, 0, v157
v_pk_mul_f32 v[86:87], v[86:87], v[150:151]
v_cvt_pk_bf16_f32 v72, v84, v85
v_max_f32 v90, 0, v158
v_max_f32 v91, 0, v159
v_pk_mul_f32 v[88:89], v[88:89], v[156:157]
v_cvt_pk_bf16_f32 v73, v86, v87
v_pk_mul_f32 v[90:91], v[90:91], v[158:159]
v_cvt_pk_bf16_f32 v74, v88, v89
v_cvt_pk_bf16_f32 v75, v90, v91
buffer_store_dwordx4 v[68:71], v11, s[44:47], s19 offen offset:0 sc1
buffer_store_dwordx4 v[72:75], v11, s[44:47], s19 offen offset:1024 sc1
v_max_f32 v84, 0, v160
v_max_f32 v85, 0, v161
v_max_f32 v86, 0, v162
v_max_f32 v87, 0, v163
v_pk_mul_f32 v[84:85], v[84:85], v[160:161]
v_max_f32 v88, 0, v168
v_max_f32 v89, 0, v169
v_pk_mul_f32 v[86:87], v[86:87], v[162:163]
v_cvt_pk_bf16_f32 v76, v84, v85
v_max_f32 v90, 0, v170
v_max_f32 v91, 0, v171
v_pk_mul_f32 v[88:89], v[88:89], v[168:169]
v_cvt_pk_bf16_f32 v77, v86, v87
v_max_f32 v84, 0, v164
v_max_f32 v85, 0, v165
v_pk_mul_f32 v[90:91], v[90:91], v[170:171]
v_cvt_pk_bf16_f32 v78, v88, v89
v_max_f32 v86, 0, v166
v_max_f32 v87, 0, v167
v_pk_mul_f32 v[84:85], v[84:85], v[164:165]
v_cvt_pk_bf16_f32 v79, v90, v91
v_max_f32 v88, 0, v172
v_max_f32 v89, 0, v173
v_pk_mul_f32 v[86:87], v[86:87], v[166:167]
v_cvt_pk_bf16_f32 v80, v84, v85
v_max_f32 v90, 0, v174
v_max_f32 v91, 0, v175
v_pk_mul_f32 v[88:89], v[88:89], v[172:173]
v_cvt_pk_bf16_f32 v81, v86, v87
v_pk_mul_f32 v[90:91], v[90:91], v[174:175]
v_cvt_pk_bf16_f32 v82, v88, v89
v_cvt_pk_bf16_f32 v83, v90, v91
buffer_store_dwordx4 v[76:79], v11, s[44:47], s19 offen offset:2048 sc1
buffer_store_dwordx4 v[80:83], v11, s[44:47], s19 offen offset:3072 sc1
v_max_f32 v84, 0, v176
v_max_f32 v85, 0, v177
v_max_f32 v86, 0, v178
v_max_f32 v87, 0, v179
v_pk_mul_f32 v[84:85], v[84:85], v[176:177]
v_max_f32 v88, 0, v184
v_max_f32 v89, 0, v185
v_pk_mul_f32 v[86:87], v[86:87], v[178:179]
v_cvt_pk_bf16_f32 v68, v84, v85
v_max_f32 v90, 0, v186
v_max_f32 v91, 0, v187
v_pk_mul_f32 v[88:89], v[88:89], v[184:185]
v_cvt_pk_bf16_f32 v69, v86, v87
v_max_f32 v84, 0, v180
v_max_f32 v85, 0, v181
v_pk_mul_f32 v[90:91], v[90:91], v[186:187]
v_cvt_pk_bf16_f32 v70, v88, v89
v_max_f32 v86, 0, v182
v_max_f32 v87, 0, v183
v_pk_mul_f32 v[84:85], v[84:85], v[180:181]
v_cvt_pk_bf16_f32 v71, v90, v91
v_max_f32 v88, 0, v188
v_max_f32 v89, 0, v189
v_pk_mul_f32 v[86:87], v[86:87], v[182:183]
v_cvt_pk_bf16_f32 v72, v84, v85
v_max_f32 v90, 0, v190
v_max_f32 v91, 0, v191
v_pk_mul_f32 v[88:89], v[88:89], v[188:189]
v_cvt_pk_bf16_f32 v73, v86, v87
v_pk_mul_f32 v[90:91], v[90:91], v[190:191]
v_cvt_pk_bf16_f32 v74, v88, v89
v_cvt_pk_bf16_f32 v75, v90, v91
buffer_store_dwordx4 v[68:71], v11, s[44:47], s18 offen offset:0 sc1
buffer_store_dwordx4 v[72:75], v11, s[44:47], s18 offen offset:1024 sc1
v_mov_b32 v10, 162816
v_mov_b32 v13, 1
s_mov_b64 exec, 1
ds_add_u32 v10, v13 offset:8
s_mov_b64 exec, -1
s_branch L_g_issued
L_gD:
s_lshl_b32 s17, s16, 12
s_sub_u32 s17, 16384, s17
v_add_u32 v4, s17, v2
v_add_u32 v6, 28672, v2
v_add_u32 v8, 28672, v4
v_add_u32 v5, s17, v3
v_add_u32 v7, 28672, v3
v_add_u32 v9, 28672, v5
s_bitcmp1_b32 s25, 0
s_cselect_b32 s48, -1.0, 1.0
s_mov_b32 s18, 0
s_mov_b32 s49, 0xffff0000
s_mov_b32 s50, 0
s_mov_b32 s51, 1
s_barrier
ds_read_b128 v[192:195], v2 offset:0
ds_read_b128 v[196:199], v6 offset:0
ds_read_b128 v[200:203], v2 offset:2048
ds_read_b128 v[204:207], v6 offset:2048
ds_read_b128 v[208:211], v3 offset:0
ds_read_b128 v[212:215], v7 offset:0
ds_read_b128 v[216:219], v3 offset:2048
ds_read_b128 v[220:223], v7 offset:2048
ds_read_b128 v[32:35], v4 offset:0
ds_read_b128 v[36:39], v4 offset:2048
ds_read_b128 v[40:43], v4 offset:4096
ds_read_b128 v[44:47], v4 offset:6144
ds_read_b128 v[48:51], v4 offset:8192
ds_read_b128 v[52:55], v4 offset:10240
ds_read_b128 v[56:59], v8 offset:0
ds_read_b128 v[60:63], v8 offset:2048
ds_read_b128 v[64:67], v8 offset:4096
ds_read_b128 v[68:71], v8 offset:6144
s_waitcnt lgkmcnt(14)
v_lshlrev_b32 v224, 16, v192
v_lshlrev_b32 v226, 16, v196
v_and_b32 v225, s49, v192
v_and_b32 v227, s49, v196
v_lshlrev_b32 v228, 16, v193
v_lshlrev_b32 v230, 16, v197
v_fmac_f32 v224, s48, v226
v_fmac_f32 v225, s48, v227
v_and_b32 v229, s49, v193
v_and_b32 v231, s49, v197
v_fmac_f32 v228, s48, v230
v_fmac_f32 v229, s48, v231
v_cvt_pk_bf16_f32 v16, v224, v225
v_cvt_pk_bf16_f32 v17, v228, v229
v_lshlrev_b32 v232, 16, v194
v_lshlrev_b32 v234, 16, v198
v_and_b32 v233, s49, v194
v_and_b32 v235, s49, v198
v_lshlrev_b32 v236, 16, v195
v_lshlrev_b32 v238, 16, v199
v_fmac_f32 v232, s48, v234
v_fmac_f32 v233, s48, v235
v_and_b32 v237, s49, v195
v_and_b32 v239, s49, v199
v_fmac_f32 v236, s48, v238
v_fmac_f32 v237, s48, v239
v_cvt_pk_bf16_f32 v18, v232, v233
v_cvt_pk_bf16_f32 v19, v236, v237
v_lshlrev_b32 v224, 16, v200
v_lshlrev_b32 v226, 16, v204
v_and_b32 v225, s49, v200
v_and_b32 v227, s49, v204
v_lshlrev_b32 v228, 16, v201
v_lshlrev_b32 v230, 16, v205
v_fmac_f32 v224, s48, v226
v_fmac_f32 v225, s48, v227
v_and_b32 v229, s49, v201
v_and_b32 v231, s49, v205
v_fmac_f32 v228, s48, v230
v_fmac_f32 v229, s48, v231
v_cvt_pk_bf16_f32 v20, v224, v225
v_cvt_pk_bf16_f32 v21, v228, v229
v_lshlrev_b32 v232, 16, v202
v_lshlrev_b32 v234, 16, v206
v_and_b32 v233, s49, v202
v_and_b32 v235, s49, v206
v_lshlrev_b32 v236, 16, v203
v_lshlrev_b32 v238, 16, v207
v_fmac_f32 v232, s48, v234
v_fmac_f32 v233, s48, v235
v_and_b32 v237, s49, v203
v_and_b32 v239, s49, v207
v_fmac_f32 v236, s48, v238
v_fmac_f32 v237, s48, v239
v_cvt_pk_bf16_f32 v22, v232, v233
v_cvt_pk_bf16_f32 v23, v236, v237
s_barrier
L_gD_loop:
s_waitcnt lgkmcnt(0)
s_nop 0
v_mfma_f32_16x16x32_bf16 v[112:115], v[16:19], v[32:35], v[112:115]
ds_read_b128 v[72:75], v5 offset:0
ds_read_b128 v[76:79], v5 offset:2048
ds_read_b128 v[80:83], v5 offset:4096
ds_read_b128 v[84:87], v5 offset:6144
v_mfma_f32_16x16x32_bf16 v[116:119], v[20:23], v[32:35], v[116:119]
ds_read_b128 v[88:91], v5 offset:8192
ds_read_b128 v[92:95], v5 offset:10240
ds_read_b128 v[96:99], v9 offset:0
ds_read_b128 v[100:103], v9 offset:2048
v_mfma_f32_16x16x32_bf16 v[120:123], v[16:19], v[36:39], v[120:123]
ds_read_b128 v[104:107], v9 offset:4096
ds_read_b128 v[108:111], v9 offset:6144
s_add_u32 s18, s18, 1
s_add_u32 s50, s50, 2
s_cmp_ge_u32 s50, 5
s_mov_b32 s52, 57344
s_cselect_b32 s52, 0xfffeb000, s52
s_cselect_b32 s17, 5, 0
s_sub_u32 s50, s50, s17
s_add_u32 s51, s51, 2
s_cmp_ge_u32 s51, 5
s_mov_b32 s53, 57344
s_cselect_b32 s53, 0xfffeb000, s53
s_cselect_b32 s17, 5, 0
s_sub_u32 s51, s51, s17
v_lshlrev_b32 v224, 16, v208
v_mfma_f32_16x16x32_bf16 v[124:127], v[20:23], v[36:39], v[124:127]
v_lshlrev_b32 v226, 16, v212
v_and_b32 v225, s49, v208
v_and_b32 v227, s49, v212
v_lshlrev_b32 v228, 16, v209
v_mfma_f32_16x16x32_bf16 v[128:131], v[16:19], v[40:43], v[128:131]
v_lshlrev_b32 v230, 16, v213
v_fmac_f32 v224, s48, v226
v_fmac_f32 v225, s48, v227
v_and_b32 v229, s49, v209
v_mfma_f32_16x16x32_bf16 v[132:135], v[20:23], v[40:43], v[132:135]
v_and_b32 v231, s49, v213
v_fmac_f32 v228, s48, v230
v_fmac_f32 v229, s48, v231
v_cvt_pk_bf16_f32 v24, v224, v225
v_mfma_f32_16x16x32_bf16 v[136:139], v[16:19], v[44:47], v[136:139]
v_cvt_pk_bf16_f32 v25, v228, v229
v_lshlrev_b32 v232, 16, v210
v_lshlrev_b32 v234, 16, v214
v_and_b32 v233, s49, v210
v_mfma_f32_16x16x32_bf16 v[140:143], v[20:23], v[44:47], v[140:143]
v_and_b32 v235, s49, v214
v_lshlrev_b32 v236, 16, v211
v_lshlrev_b32 v238, 16, v215
v_mfma_f32_16x16x32_bf16 v[144:147], v[16:19], v[48:51], v[144:147]
v_fmac_f32 v232, s48, v234
v_fmac_f32 v233, s48, v235
v_and_b32 v237, s49, v211
v_mfma_f32_16x16x32_bf16 v[148:151], v[20:23], v[48:51], v[148:151]
v_and_b32 v239, s49, v215
v_fmac_f32 v236, s48, v238
v_fmac_f32 v237, s48, v239
v_mfma_f32_16x16x32_bf16 v[152:155], v[16:19], v[52:55], v[152:155]
v_cvt_pk_bf16_f32 v26, v232, v233
v_cvt_pk_bf16_f32 v27, v236, v237
v_lshlrev_b32 v224, 16, v216
v_mfma_f32_16x16x32_bf16 v[156:159], v[20:23], v[52:55], v[156:159]
v_lshlrev_b32 v226, 16, v220
v_and_b32 v225, s49, v216
v_and_b32 v227, s49, v220
v_mfma_f32_16x16x32_bf16 v[160:163], v[16:19], v[56:59], v[160:163]
v_lshlrev_b32 v228, 16, v217
v_lshlrev_b32 v230, 16, v221
v_fmac_f32 v224, s48, v226
v_mfma_f32_16x16x32_bf16 v[164:167], v[20:23], v[56:59], v[164:167]
v_fmac_f32 v225, s48, v227
v_and_b32 v229, s49, v217
v_and_b32 v231, s49, v221
v_mfma_f32_16x16x32_bf16 v[168:171], v[16:19], v[60:63], v[168:171]
v_fmac_f32 v228, s48, v230
v_fmac_f32 v229, s48, v231
v_cvt_pk_bf16_f32 v28, v224, v225
v_mfma_f32_16x16x32_bf16 v[172:175], v[20:23], v[60:63], v[172:175]
v_cvt_pk_bf16_f32 v29, v228, v229
v_lshlrev_b32 v232, 16, v218
v_lshlrev_b32 v234, 16, v222
v_mfma_f32_16x16x32_bf16 v[176:179], v[16:19], v[64:67], v[176:179]
v_and_b32 v233, s49, v218
v_and_b32 v235, s49, v222
v_lshlrev_b32 v236, 16, v219
v_mfma_f32_16x16x32_bf16 v[180:183], v[20:23], v[64:67], v[180:183]
v_lshlrev_b32 v238, 16, v223
v_fmac_f32 v232, s48, v234
v_fmac_f32 v233, s48, v235
v_mfma_f32_16x16x32_bf16 v[184:187], v[16:19], v[68:71], v[184:187]
v_and_b32 v237, s49, v219
v_and_b32 v239, s49, v223
v_fmac_f32 v236, s48, v238
v_mfma_f32_16x16x32_bf16 v[188:191], v[20:23], v[68:71], v[188:191]
v_fmac_f32 v237, s48, v239
v_cvt_pk_bf16_f32 v30, v232, v233
v_cvt_pk_bf16_f32 v31, v236, v237
s_waitcnt lgkmcnt(0)
s_cmp_eq_u32 s18, 5
s_cbranch_scc1 L_gD_last
v_mfma_f32_16x16x32_bf16 v[112:115], v[24:27], v[72:75], v[112:115]
v_add_u32 v2, s52, v2
v_add_u32 v6, s53, v6
v_add_u32 v3, s52, v3
v_add_u32 v7, s53, v7
v_add_u32 v4, s52, v4
v_add_u32 v8, s53, v8
v_add_u32 v5, s52, v5
v_add_u32 v9, s53, v9
v_mfma_f32_16x16x32_bf16 v[116:119], v[28:31], v[72:75], v[116:119]
s_barrier
v_mfma_f32_16x16x32_bf16 v[120:123], v[24:27], v[76:79], v[120:123]
ds_read_b128 v[192:195], v2 offset:0
ds_read_b128 v[196:199], v6 offset:0
ds_read_b128 v[200:203], v2 offset:2048
v_mfma_f32_16x16x32_bf16 v[124:127], v[28:31], v[76:79], v[124:127]
ds_read_b128 v[204:207], v6 offset:2048
ds_read_b128 v[208:211], v3 offset:0
ds_read_b128 v[212:215], v7 offset:0
v_mfma_f32_16x16x32_bf16 v[128:131], v[24:27], v[80:83], v[128:131]
ds_read_b128 v[216:219], v3 offset:2048
ds_read_b128 v[220:223], v7 offset:2048
v_mfma_f32_16x16x32_bf16 v[132:135], v[28:31], v[80:83], v[132:135]
ds_read_b128 v[32:35], v4 offset:0
ds_read_b128 v[36:39], v4 offset:2048
v_mfma_f32_16x16x32_bf16 v[136:139], v[24:27], v[84:87], v[136:139]
ds_read_b128 v[40:43], v4 offset:4096
ds_read_b128 v[44:47], v4 offset:6144
v_mfma_f32_16x16x32_bf16 v[140:143], v[28:31], v[84:87], v[140:143]
ds_read_b128 v[48:51], v4 offset:8192
ds_read_b128 v[52:55], v4 offset:10240
v_mfma_f32_16x16x32_bf16 v[144:147], v[24:27], v[88:91], v[144:147]
ds_read_b128 v[56:59], v8 offset:0
ds_read_b128 v[60:63], v8 offset:2048
v_mfma_f32_16x16x32_bf16 v[148:151], v[28:31], v[88:91], v[148:151]
ds_read_b128 v[64:67], v8 offset:4096
ds_read_b128 v[68:71], v8 offset:6144
s_waitcnt lgkmcnt(14)
v_mfma_f32_16x16x32_bf16 v[152:155], v[24:27], v[92:95], v[152:155]
v_lshlrev_b32 v224, 16, v192
v_lshlrev_b32 v226, 16, v196
v_and_b32 v225, s49, v192
v_and_b32 v227, s49, v196
v_lshlrev_b32 v228, 16, v193
v_lshlrev_b32 v230, 16, v197
v_mfma_f32_16x16x32_bf16 v[156:159], v[28:31], v[92:95], v[156:159]
v_fmac_f32 v224, s48, v226
v_fmac_f32 v225, s48, v227
v_and_b32 v229, s49, v193
v_and_b32 v231, s49, v197
v_fmac_f32 v228, s48, v230
v_fmac_f32 v229, s48, v231
v_mfma_f32_16x16x32_bf16 v[160:163], v[24:27], v[96:99], v[160:163]
v_cvt_pk_bf16_f32 v16, v224, v225
v_cvt_pk_bf16_f32 v17, v228, v229
v_lshlrev_b32 v232, 16, v194
v_lshlrev_b32 v234, 16, v198
v_and_b32 v233, s49, v194
v_and_b32 v235, s49, v198
v_mfma_f32_16x16x32_bf16 v[164:167], v[28:31], v[96:99], v[164:167]
v_lshlrev_b32 v236, 16, v195
v_lshlrev_b32 v238, 16, v199
v_fmac_f32 v232, s48, v234
v_fmac_f32 v233, s48, v235
v_and_b32 v237, s49, v195
v_and_b32 v239, s49, v199
v_mfma_f32_16x16x32_bf16 v[168:171], v[24:27], v[100:103], v[168:171]
v_fmac_f32 v236, s48, v238
v_fmac_f32 v237, s48, v239
v_cvt_pk_bf16_f32 v18, v232, v233
v_cvt_pk_bf16_f32 v19, v236, v237
v_lshlrev_b32 v224, 16, v200
v_lshlrev_b32 v226, 16, v204
v_mfma_f32_16x16x32_bf16 v[172:175], v[28:31], v[100:103], v[172:175]
v_and_b32 v225, s49, v200
v_and_b32 v227, s49, v204
v_lshlrev_b32 v228, 16, v201
v_lshlrev_b32 v230, 16, v205
v_fmac_f32 v224, s48, v226
v_fmac_f32 v225, s48, v227
v_mfma_f32_16x16x32_bf16 v[176:179], v[24:27], v[104:107], v[176:179]
v_and_b32 v229, s49, v201
v_and_b32 v231, s49, v205
v_fmac_f32 v228, s48, v230
v_fmac_f32 v229, s48, v231
v_cvt_pk_bf16_f32 v20, v224, v225
v_mfma_f32_16x16x32_bf16 v[180:183], v[28:31], v[104:107], v[180:183]
v_cvt_pk_bf16_f32 v21, v228, v229
v_lshlrev_b32 v232, 16, v202
v_lshlrev_b32 v234, 16, v206
v_and_b32 v233, s49, v202
v_and_b32 v235, s49, v206
v_mfma_f32_16x16x32_bf16 v[184:187], v[24:27], v[108:111], v[184:187]
v_lshlrev_b32 v236, 16, v203
v_lshlrev_b32 v238, 16, v207
v_fmac_f32 v232, s48, v234
v_fmac_f32 v233, s48, v235
v_and_b32 v237, s49, v203
v_mfma_f32_16x16x32_bf16 v[188:191], v[28:31], v[108:111], v[188:191]
v_and_b32 v239, s49, v207
v_fmac_f32 v236, s48, v238
v_fmac_f32 v237, s48, v239
v_cvt_pk_bf16_f32 v22, v232, v233
v_cvt_pk_bf16_f32 v23, v236, v237
s_branch L_gD_loop
L_gD_last:
s_mov_b64 exec, 1
ds_add_u32 v242, v243 offset:76
s_mov_b64 exec, -1
s_cmp_eq_u32 s29, 6
s_cselect_b32 s17, 0x4420, 0
v_mfma_f32_16x16x32_bf16 v[112:115], v[24:27], v[72:75], v[112:115]
v_mov_b32 v193, 0
v_mfma_f32_16x16x32_bf16 v[116:119], v[28:31], v[72:75], v[116:119]
v_mov_b32 v194, 0
v_mfma_f32_16x16x32_bf16 v[120:123], v[24:27], v[76:79], v[120:123]
v_mov_b32 v195, 0
v_mfma_f32_16x16x32_bf16 v[124:127], v[28:31], v[76:79], v[124:127]
v_mov_b32 v197, 0
v_mfma_f32_16x16x32_bf16 v[128:131], v[24:27], v[80:83], v[128:131]
v_mov_b32 v198, 0
v_mfma_f32_16x16x32_bf16 v[132:135], v[28:31], v[80:83], v[132:135]
v_mov_b32 v199, 0
v_mfma_f32_16x16x32_bf16 v[136:139], v[24:27], v[84:87], v[136:139]
v_mov_b32 v200, 0
v_mfma_f32_16x16x32_bf16 v[140:143], v[28:31], v[84:87], v[140:143]
v_mov_b32 v201, 0
v_mfma_f32_16x16x32_bf16 v[144:147], v[24:27], v[88:91], v[144:147]
v_mov_b32 v202, 0
v_mfma_f32_16x16x32_bf16 v[148:151], v[28:31], v[88:91], v[148:151]
v_mov_b32 v203, 0
v_mfma_f32_16x16x32_bf16 v[152:155], v[24:27], v[92:95], v[152:155]
v_writelane_b32 v200, s17, 0
v_mfma_f32_16x16x32_bf16 v[156:159], v[28:31], v[92:95], v[156:159]
ds_read_b32 v192, v240
v_mfma_f32_16x16x32_bf16 v[160:163], v[24:27], v[96:99], v[160:163]
ds_read_b32 v196, v240 offset:128
v_mfma_f32_16x16x32_bf16 v[164:167], v[28:31], v[96:99], v[164:167]
v_mfma_f32_16x16x32_bf16 v[168:171], v[24:27], v[100:103], v[168:171]
v_mfma_f32_16x16x32_bf16 v[172:175], v[28:31], v[100:103], v[172:175]
v_mfma_f32_16x16x32_bf16 v[176:179], v[24:27], v[104:107], v[176:179]
v_mfma_f32_16x16x32_bf16 v[180:183], v[28:31], v[104:107], v[180:183]
v_mfma_f32_16x16x32_bf16 v[184:187], v[24:27], v[108:111], v[184:187]
v_mfma_f32_16x16x32_bf16 v[188:191], v[28:31], v[108:111], v[188:191]
L_gD_fin:
s_waitcnt lgkmcnt(0)
v_mfma_f32_16x16x32_bf16 v[112:115], v[192:195], v[200:203], v[112:115]
v_mfma_f32_16x16x32_bf16 v[116:119], v[196:199], v[200:203], v[116:119]
v_lshrrev_b32 v12, 4, v0
s_lshl_b32 s17, s16, 7
s_add_u32 s17, s17, 161792
v_lshl_add_u32 v11, v12, 4, s17
ds_read_b128 v[40:43], v11
ds_read_b128 v[44:47], v11 offset:64
v_and_b32 v11, 15, v0
v_mul_u32_u24 v11, 272, v11
v_lshl_add_u32 v11, v12, 6, v11
s_lshl_b32 s17, s16, 4
s_add_u32 s17, s17, 86016
v_add_u32 v11, s17, v11
v_mov_b32 v10, 162816
s_mov_b32 s19, 0
L_sp51:
ds_read_b32 v13, v10 offset:76
s_waitcnt lgkmcnt(0)
v_readfirstlane_b32 s27, v13
s_add_u32 s19, s19, 1
s_cmp_gt_u32 s19, 200000
s_cbranch_scc1 L_sp51d
s_cmp_ge_u32 s27, 4
s_cbranch_scc1 L_sp51d
s_sleep 1
s_branch L_sp51
L_sp51d:
.p2align 3
v_pk_mul_f32 v[120:121], v[120:121], v[40:41]
v_pk_mul_f32 v[122:123], v[122:123], v[42:43]
v_pk_mul_f32 v[124:125], v[124:125], v[44:45]
v_pk_mul_f32 v[126:127], v[126:127], v[46:47]
v_cvt_pk_bf16_f32 v56, v120, v121
v_cvt_pk_bf16_f32 v57, v122, v123
v_cvt_pk_bf16_f32 v58, v124, v125
v_cvt_pk_bf16_f32 v59, v126, v127
ds_write_b128 v11, v[56:59] offset:4352
v_pk_mul_f32 v[128:129], v[128:129], v[40:41]
v_pk_mul_f32 v[130:131], v[130:131], v[42:43]
v_pk_mul_f32 v[132:133], v[132:133], v[44:45]
v_pk_mul_f32 v[134:135], v[134:135], v[46:47]
v_cvt_pk_bf16_f32 v60, v128, v129
v_cvt_pk_bf16_f32 v61, v130, v131
v_cvt_pk_bf16_f32 v62, v132, v133
v_cvt_pk_bf16_f32 v63, v134, v135
ds_write_b128 v11, v[60:63] offset:8704
v_pk_mul_f32 v[136:137], v[136:137], v[40:41]
v_pk_mul_f32 v[138:139], v[138:139], v[42:43]
v_pk_mul_f32 v[140:141], v[140:141], v[44:45]
v_pk_mul_f32 v[142:143], v[142:143], v[46:47]
v_cvt_pk_bf16_f32 v64, v136, v137
v_cvt_pk_bf16_f32 v65, v138, v139
v_cvt_pk_bf16_f32 v66, v140, v141
v_cvt_pk_bf16_f32 v67, v142, v143
ds_write_b128 v11, v[64:67] offset:13056
v_pk_mul_f32 v[144:145], v[144:145], v[40:41]
v_pk_mul_f32 v[146:147], v[146:147], v[42:43]
v_pk_mul_f32 v[148:149], v[148:149], v[44:45]
v_pk_mul_f32 v[150:151], v[150:151], v[46:47]
v_cvt_pk_bf16_f32 v68, v144, v145
v_cvt_pk_bf16_f32 v69, v146, v147
v_cvt_pk_bf16_f32 v70, v148, v149
v_cvt_pk_bf16_f32 v71, v150, v151
ds_write_b128 v11, v[68:71] offset:17408
v_pk_mul_f32 v[152:153], v[152:153], v[40:41]
v_pk_mul_f32 v[154:155], v[154:155], v[42:43]
v_pk_mul_f32 v[156:157], v[156:157], v[44:45]
v_pk_mul_f32 v[158:159], v[158:159], v[46:47]
v_cvt_pk_bf16_f32 v56, v152, v153
v_cvt_pk_bf16_f32 v57, v154, v155
v_cvt_pk_bf16_f32 v58, v156, v157
v_cvt_pk_bf16_f32 v59, v158, v159
ds_write_b128 v11, v[56:59] offset:21760
v_pk_mul_f32 v[160:161], v[160:161], v[40:41]
v_pk_mul_f32 v[162:163], v[162:163], v[42:43]
v_pk_mul_f32 v[164:165], v[164:165], v[44:45]
v_pk_mul_f32 v[166:167], v[166:167], v[46:47]
v_cvt_pk_bf16_f32 v60, v160, v161
v_cvt_pk_bf16_f32 v61, v162, v163
v_cvt_pk_bf16_f32 v62, v164, v165
v_cvt_pk_bf16_f32 v63, v166, v167
ds_write_b128 v11, v[60:63] offset:26112
v_pk_mul_f32 v[168:169], v[168:169], v[40:41]
v_pk_mul_f32 v[170:171], v[170:171], v[42:43]
v_pk_mul_f32 v[172:173], v[172:173], v[44:45]
v_pk_mul_f32 v[174:175], v[174:175], v[46:47]
v_cvt_pk_bf16_f32 v64, v168, v169
v_cvt_pk_bf16_f32 v65, v170, v171
v_cvt_pk_bf16_f32 v66, v172, v173
v_cvt_pk_bf16_f32 v67, v174, v175
ds_write_b128 v11, v[64:67] offset:30464
v_pk_mul_f32 v[176:177], v[176:177], v[40:41]
v_pk_mul_f32 v[178:179], v[178:179], v[42:43]
v_pk_mul_f32 v[180:181], v[180:181], v[44:45]
v_pk_mul_f32 v[182:183], v[182:183], v[46:47]
v_cvt_pk_bf16_f32 v68, v176, v177
v_cvt_pk_bf16_f32 v69, v178, v179
v_cvt_pk_bf16_f32 v70, v180, v181
v_cvt_pk_bf16_f32 v71, v182, v183
ds_write_b128 v11, v[68:71] offset:34816
v_pk_mul_f32 v[184:185], v[184:185], v[40:41]
v_pk_mul_f32 v[186:187], v[186:187], v[42:43]
v_pk_mul_f32 v[188:189], v[188:189], v[44:45]
v_pk_mul_f32 v[190:191], v[190:191], v[46:47]
v_cvt_pk_bf16_f32 v56, v184, v185
v_cvt_pk_bf16_f32 v57, v186, v187
v_cvt_pk_bf16_f32 v58, v188, v189
v_cvt_pk_bf16_f32 v59, v190, v191
ds_write_b128 v11, v[56:59] offset:39168
v_pk_mul_f32 v[112:113], v[112:113], v[40:41]
v_pk_mul_f32 v[114:115], v[114:115], v[42:43]
v_pk_mul_f32 v[116:117], v[116:117], v[44:45]
v_pk_mul_f32 v[118:119], v[118:119], v[46:47]
v_cvt_pk_bf16_f32 v60, v112, v113
v_cvt_pk_bf16_f32 v61, v114, v115
v_cvt_pk_bf16_f32 v62, v116, v117
v_cvt_pk_bf16_f32 v63, v118, v119
ds_write_b128 v11, v[60:63] offset:0
s_waitcnt lgkmcnt(0)
v_mov_b32 v13, 1
s_mov_b64 exec, 1
ds_add_u32 v10, v13 offset:4
s_mov_b64 exec, -1
v_lshrrev_b32 v12, 4, v0
s_mul_i32 s17, s16, 40
v_add_u32 v13, s17, v12
v_mul_u32_u24 v11, 272, v13
v_and_b32 v14, 15, v0
v_lshl_add_u32 v11, v14, 4, v11
v_add_u32 v11, 86016, v11
v_lshlrev_b32 v12, 13, v12
v_lshl_add_u32 v12, v14, 4, v12
s_mul_i32 s18, s23, 1376256
s_add_u32 s18, s18, 11534336
s_lshl_b32 s48, s26, 8
s_add_u32 s18, s18, s48
s_and_b32 s48, s25, 1
s_lshl_b32 s48, s48, 12
s_lshl_b32 s49, s17, 13
s_add_u32 s48, s48, s49
s_add_u32 s52, s48, s18
s_cmp_eq_u32 s29, 6
s_cbranch_scc0 L_g_no320
s_cmp_eq_u32 s16, 3
s_cbranch_scc0 L_g_no320
v_and_b32 v20, 3, v0
v_lshlrev_b32 v20, 7, v20
v_bfe_u32 v21, v0, 2, 2
v_lshl_add_u32 v20, v21, 4, v20
v_add_u32 v20, 162304, v20
ds_read_b128 v[24:27], v20
ds_read_b128 v[28:31], v20 offset:64
s_add_u32 s50, s18, 1310720
s_waitcnt lgkmcnt(0)
v_cvt_pk_bf16_f32 v24, v24, v25
v_cvt_pk_bf16_f32 v25, v26, v27
v_cvt_pk_bf16_f32 v26, v28, v29
v_cvt_pk_bf16_f32 v27, v30, v31
s_mov_b64 exec, 0xffff
buffer_store_dwordx4 v[24:27], v12, s[44:47], s50 offen sc1
s_mov_b64 exec, -1
L_g_no320:
s_mov_b32 s19, 0
L_sp52:
ds_read_b32 v13, v10 offset:4
s_waitcnt lgkmcnt(0)
v_readfirstlane_b32 s27, v13
s_add_u32 s19, s19, 1
s_cmp_gt_u32 s19, 200000
s_cbranch_scc1 L_sp52d
s_cmp_ge_u32 s27, 4
s_cbranch_scc1 L_sp52d
s_sleep 1
s_branch L_sp52
L_sp52d:
ds_read_b128 v[112:115], v11 offset:0
ds_read_b128 v[116:119], v11 offset:1088
ds_read_b128 v[120:123], v11 offset:2176
ds_read_b128 v[124:127], v11 offset:3264
ds_read_b128 v[128:131], v11 offset:4352
ds_read_b128 v[132:135], v11 offset:5440
ds_read_b128 v[136:139], v11 offset:6528
ds_read_b128 v[140:143], v11 offset:7616
ds_read_b128 v[144:147], v11 offset:8704
ds_read_b128 v[148:151], v11 offset:9792
s_waitcnt lgkmcnt(9)
buffer_store_dwordx4 v[112:115], v12, s[44:47], s52 offen sc1
s_add_u32 s52, s52, 32768
s_waitcnt lgkmcnt(8)
buffer_store_dwordx4 v[116:119], v12, s[44:47], s52 offen sc1
s_add_u32 s52, s52, 32768
s_waitcnt lgkmcnt(7)
buffer_store_dwordx4 v[120:123], v12, s[44:47], s52 offen sc1
s_add_u32 s52, s52, 32768
s_waitcnt lgkmcnt(6)
buffer_store_dwordx4 v[124:127], v12, s[44:47], s52 offen sc1
s_add_u32 s52, s52, 32768
s_waitcnt lgkmcnt(5)
buffer_store_dwordx4 v[128:131], v12, s[44:47], s52 offen sc1
s_add_u32 s52, s52, 32768
s_waitcnt lgkmcnt(4)
buffer_store_dwordx4 v[132:135], v12, s[44:47], s52 offen sc1
s_add_u32 s52, s52, 32768
s_waitcnt lgkmcnt(3)
buffer_store_dwordx4 v[136:139], v12, s[44:47], s52 offen sc1
s_add_u32 s52, s52, 32768
s_waitcnt lgkmcnt(2)
buffer_store_dwordx4 v[140:143], v12, s[44:47], s52 offen sc1
s_add_u32 s52, s52, 32768
s_waitcnt lgkmcnt(1)
buffer_store_dwordx4 v[144:147], v12, s[44:47], s52 offen sc1
s_add_u32 s52, s52, 32768
s_waitcnt lgkmcnt(0)
buffer_store_dwordx4 v[148:151], v12, s[44:47], s52 offen sc1
s_add_u32 s52, s52, 32768
v_mov_b32 v13, 1
s_mov_b64 exec, 1
ds_add_u32 v10, v13 offset:8
s_mov_b64 exec, -1
s_branch L_g_issued
L_g4:
s_mov_b32 s18, 0
s_mov_b32 s17, 73728
s_barrier
ds_read_b128 v[16:19], v2 offset:0
ds_read_b128 v[20:23], v2 offset:2048
ds_read_b64_tr_b16 v[24:25], v4 offset:0
ds_read_b64_tr_b16 v[26:27], v4 offset:1024
ds_read_b64_tr_b16 v[28:29], v5 offset:0
ds_read_b64_tr_b16 v[30:31], v5 offset:1024
ds_read_b64_tr_b16 v[32:33], v6 offset:0
ds_read_b64_tr_b16 v[34:35], v6 offset:1024
ds_read_b64_tr_b16 v[36:37], v7 offset:0
ds_read_b64_tr_b16 v[38:39], v7 offset:1024
ds_read_b64_tr_b16 v[40:41], v8 offset:0
ds_read_b64_tr_b16 v[42:43], v8 offset:1024
ds_read_b64_tr_b16 v[44:45], v9 offset:0
ds_read_b64_tr_b16 v[46:47], v9 offset:1024
ds_read_b64_tr_b16 v[48:49], v10 offset:0
ds_read_b64_tr_b16 v[50:51], v10 offset:1024
ds_read_b64_tr_b16 v[52:53], v11 offset:0
ds_read_b64_tr_b16 v[54:55], v11 offset:1024
.p2align 3
L_g4_loop:
s_waitcnt lgkmcnt(0)
s_nop 0
v_mfma_f32_16x16x32_bf16 v[112:115], v[24:27], v[16:19], v[112:115]
ds_read_b128 v[64:67], v3 offset:0
ds_read_b128 v[68:71], v3 offset:2048
v_mfma_f32_16x16x32_bf16 v[116:119], v[24:27], v[20:23], v[116:119]
ds_read_b64_tr_b16 v[72:73], v4 offset:8192
ds_read_b64_tr_b16 v[74:75], v4 offset:9216
v_mfma_f32_16x16x32_bf16 v[120:123], v[28:31], v[16:19], v[120:123]
ds_read_b64_tr_b16 v[76:77], v5 offset:8192
ds_read_b64_tr_b16 v[78:79], v5 offset:9216
v_mfma_f32_16x16x32_bf16 v[124:127], v[28:31], v[20:23], v[124:127]
ds_read_b64_tr_b16 v[80:81], v6 offset:8192
ds_read_b64_tr_b16 v[82:83], v6 offset:9216
v_mfma_f32_16x16x32_bf16 v[128:131], v[32:35], v[16:19], v[128:131]
ds_read_b64_tr_b16 v[84:85], v7 offset:8192
ds_read_b64_tr_b16 v[86:87], v7 offset:9216
v_mfma_f32_16x16x32_bf16 v[132:135], v[32:35], v[20:23], v[132:135]
ds_read_b64_tr_b16 v[88:89], v8 offset:8192
ds_read_b64_tr_b16 v[90:91], v8 offset:9216
v_mfma_f32_16x16x32_bf16 v[136:139], v[36:39], v[16:19], v[136:139]
ds_read_b64_tr_b16 v[92:93], v9 offset:8192
v_mfma_f32_16x16x32_bf16 v[140:143], v[36:39], v[20:23], v[140:143]
ds_read_b64_tr_b16 v[94:95], v9 offset:9216
v_mfma_f32_16x16x32_bf16 v[144:147], v[40:43], v[16:19], v[144:147]
ds_read_b64_tr_b16 v[96:97], v10 offset:8192
v_mfma_f32_16x16x32_bf16 v[148:151], v[40:43], v[20:23], v[148:151]
ds_read_b64_tr_b16 v[98:99], v10 offset:9216
v_mfma_f32_16x16x32_bf16 v[152:155], v[44:47], v[16:19], v[152:155]
ds_read_b64_tr_b16 v[100:101], v11 offset:8192
v_mfma_f32_16x16x32_bf16 v[156:159], v[44:47], v[20:23], v[156:159]
ds_read_b64_tr_b16 v[102:103], v11 offset:9216
v_mfma_f32_16x16x32_bf16 v[160:163], v[48:51], v[16:19], v[160:163]
v_mfma_f32_16x16x32_bf16 v[164:167], v[48:51], v[20:23], v[164:167]
v_mfma_f32_16x16x32_bf16 v[168:171], v[52:55], v[16:19], v[168:171]
v_mfma_f32_16x16x32_bf16 v[172:175], v[52:55], v[20:23], v[172:175]
s_waitcnt lgkmcnt(0)
s_nop 0
v_mfma_f32_16x16x32_bf16 v[112:115], v[72:75], v[64:67], v[112:115]
s_add_u32 s18, s18, 1
s_cmp_eq_u32 s18, 5
v_mfma_f32_16x16x32_bf16 v[116:119], v[72:75], v[68:71], v[116:119]
s_barrier
s_nop 0
v_mfma_f32_16x16x32_bf16 v[120:123], v[76:79], v[64:67], v[120:123]
ds_read_b128 v[16:19], v2 offset:36864
ds_read_b128 v[20:23], v2 offset:38912
v_mfma_f32_16x16x32_bf16 v[124:127], v[76:79], v[68:71], v[124:127]
ds_read_b64_tr_b16 v[24:25], v4 offset:36864
ds_read_b64_tr_b16 v[26:27], v4 offset:37888
v_mfma_f32_16x16x32_bf16 v[128:131], v[80:83], v[64:67], v[128:131]
ds_read_b64_tr_b16 v[28:29], v5 offset:36864
ds_read_b64_tr_b16 v[30:31], v5 offset:37888
v_mfma_f32_16x16x32_bf16 v[132:135], v[80:83], v[68:71], v[132:135]
ds_read_b64_tr_b16 v[32:33], v6 offset:36864
ds_read_b64_tr_b16 v[34:35], v6 offset:37888
v_mfma_f32_16x16x32_bf16 v[136:139], v[84:87], v[64:67], v[136:139]
ds_read_b64_tr_b16 v[36:37], v7 offset:36864
ds_read_b64_tr_b16 v[38:39], v7 offset:37888
v_mfma_f32_16x16x32_bf16 v[140:143], v[84:87], v[68:71], v[140:143]
ds_read_b64_tr_b16 v[40:41], v8 offset:36864
ds_read_b64_tr_b16 v[42:43], v8 offset:37888
v_mfma_f32_16x16x32_bf16 v[144:147], v[88:91], v[64:67], v[144:147]
ds_read_b64_tr_b16 v[44:45], v9 offset:36864
ds_read_b64_tr_b16 v[46:47], v9 offset:37888
v_mfma_f32_16x16x32_bf16 v[148:151], v[88:91], v[68:71], v[148:151]
ds_read_b64_tr_b16 v[48:49], v10 offset:36864
ds_read_b64_tr_b16 v[50:51], v10 offset:37888
v_mfma_f32_16x16x32_bf16 v[152:155], v[92:95], v[64:67], v[152:155]
ds_read_b64_tr_b16 v[52:53], v11 offset:36864
v_mfma_f32_16x16x32_bf16 v[156:159], v[92:95], v[68:71], v[156:159]
ds_read_b64_tr_b16 v[54:55], v11 offset:37888
v_mfma_f32_16x16x32_bf16 v[160:163], v[96:99], v[64:67], v[160:163]
v_mfma_f32_16x16x32_bf16 v[164:167], v[96:99], v[68:71], v[164:167]
v_mfma_f32_16x16x32_bf16 v[168:171], v[100:103], v[64:67], v[168:171]
v_mfma_f32_16x16x32_bf16 v[172:175], v[100:103], v[68:71], v[172:175]
s_waitcnt lgkmcnt(0)
s_nop 0
v_mfma_f32_16x16x32_bf16 v[112:115], v[24:27], v[16:19], v[112:115]
ds_read_b128 v[64:67], v3 offset:36864
ds_read_b128 v[68:71], v3 offset:38912
v_mfma_f32_16x16x32_bf16 v[116:119], v[24:27], v[20:23], v[116:119]
ds_read_b64_tr_b16 v[72:73], v4 offset:45056
ds_read_b64_tr_b16 v[74:75], v4 offset:46080
v_mfma_f32_16x16x32_bf16 v[120:123], v[28:31], v[16:19], v[120:123]
ds_read_b64_tr_b16 v[76:77], v5 offset:45056
ds_read_b64_tr_b16 v[78:79], v5 offset:46080
v_mfma_f32_16x16x32_bf16 v[124:127], v[28:31], v[20:23], v[124:127]
ds_read_b64_tr_b16 v[80:81], v6 offset:45056
ds_read_b64_tr_b16 v[82:83], v6 offset:46080
v_mfma_f32_16x16x32_bf16 v[128:131], v[32:35], v[16:19], v[128:131]
ds_read_b64_tr_b16 v[84:85], v7 offset:45056
ds_read_b64_tr_b16 v[86:87], v7 offset:46080
v_mfma_f32_16x16x32_bf16 v[132:135], v[32:35], v[20:23], v[132:135]
ds_read_b64_tr_b16 v[88:89], v8 offset:45056
ds_read_b64_tr_b16 v[90:91], v8 offset:46080
v_mfma_f32_16x16x32_bf16 v[136:139], v[36:39], v[16:19], v[136:139]
ds_read_b64_tr_b16 v[92:93], v9 offset:45056
v_mfma_f32_16x16x32_bf16 v[140:143], v[36:39], v[20:23], v[140:143]
ds_read_b64_tr_b16 v[94:95], v9 offset:46080
v_mfma_f32_16x16x32_bf16 v[144:147], v[40:43], v[16:19], v[144:147]
ds_read_b64_tr_b16 v[96:97], v10 offset:45056
v_mfma_f32_16x16x32_bf16 v[148:151], v[40:43], v[20:23], v[148:151]
ds_read_b64_tr_b16 v[98:99], v10 offset:46080
v_mfma_f32_16x16x32_bf16 v[152:155], v[44:47], v[16:19], v[152:155]
ds_read_b64_tr_b16 v[100:101], v11 offset:45056
v_mfma_f32_16x16x32_bf16 v[156:159], v[44:47], v[20:23], v[156:159]
ds_read_b64_tr_b16 v[102:103], v11 offset:46080
v_mfma_f32_16x16x32_bf16 v[160:163], v[48:51], v[16:19], v[160:163]
v_add_u32 v2, s17, v2
v_add_u32 v3, s17, v3
v_add_u32 v4, s17, v4
v_mfma_f32_16x16x32_bf16 v[164:167], v[48:51], v[20:23], v[164:167]
v_add_u32 v5, s17, v5
v_add_u32 v6, s17, v6
v_add_u32 v7, s17, v7
v_mfma_f32_16x16x32_bf16 v[168:171], v[52:55], v[16:19], v[168:171]
v_add_u32 v8, s17, v8
v_add_u32 v9, s17, v9
v_mfma_f32_16x16x32_bf16 v[172:175], v[52:55], v[20:23], v[172:175]
v_add_u32 v10, s17, v10
v_add_u32 v11, s17, v11
s_waitcnt lgkmcnt(0)
s_nop 0
v_mfma_f32_16x16x32_bf16 v[112:115], v[72:75], v[64:67], v[112:115]
s_cbranch_scc1 L_g4_fin
s_sub_u32 s17, 0, s17
v_mfma_f32_16x16x32_bf16 v[116:119], v[72:75], v[68:71], v[116:119]
s_barrier
s_nop 0
v_mfma_f32_16x16x32_bf16 v[120:123], v[76:79], v[64:67], v[120:123]
ds_read_b128 v[16:19], v2 offset:0
ds_read_b128 v[20:23], v2 offset:2048
v_mfma_f32_16x16x32_bf16 v[124:127], v[76:79], v[68:71], v[124:127]
ds_read_b64_tr_b16 v[24:25], v4 offset:0
ds_read_b64_tr_b16 v[26:27], v4 offset:1024
v_mfma_f32_16x16x32_bf16 v[128:131], v[80:83], v[64:67], v[128:131]
ds_read_b64_tr_b16 v[28:29], v5 offset:0
ds_read_b64_tr_b16 v[30:31], v5 offset:1024
v_mfma_f32_16x16x32_bf16 v[132:135], v[80:83], v[68:71], v[132:135]
ds_read_b64_tr_b16 v[32:33], v6 offset:0
ds_read_b64_tr_b16 v[34:35], v6 offset:1024
v_mfma_f32_16x16x32_bf16 v[136:139], v[84:87], v[64:67], v[136:139]
ds_read_b64_tr_b16 v[36:37], v7 offset:0
ds_read_b64_tr_b16 v[38:39], v7 offset:1024
v_mfma_f32_16x16x32_bf16 v[140:143], v[84:87], v[68:71], v[140:143]
ds_read_b64_tr_b16 v[40:41], v8 offset:0
ds_read_b64_tr_b16 v[42:43], v8 offset:1024
v_mfma_f32_16x16x32_bf16 v[144:147], v[88:91], v[64:67], v[144:147]
ds_read_b64_tr_b16 v[44:45], v9 offset:0
ds_read_b64_tr_b16 v[46:47], v9 offset:1024
v_mfma_f32_16x16x32_bf16 v[148:151], v[88:91], v[68:71], v[148:151]
ds_read_b64_tr_b16 v[48:49], v10 offset:0
ds_read_b64_tr_b16 v[50:51], v10 offset:1024
v_mfma_f32_16x16x32_bf16 v[152:155], v[92:95], v[64:67], v[152:155]
ds_read_b64_tr_b16 v[52:53], v11 offset:0
v_mfma_f32_16x16x32_bf16 v[156:159], v[92:95], v[68:71], v[156:159]
ds_read_b64_tr_b16 v[54:55], v11 offset:1024
v_mfma_f32_16x16x32_bf16 v[160:163], v[96:99], v[64:67], v[160:163]
v_mfma_f32_16x16x32_bf16 v[164:167], v[96:99], v[68:71], v[164:167]
v_mfma_f32_16x16x32_bf16 v[168:171], v[100:103], v[64:67], v[168:171]
v_mfma_f32_16x16x32_bf16 v[172:175], v[100:103], v[68:71], v[172:175]
s_branch L_g4_loop
L_g4_fin:
v_mfma_f32_16x16x32_bf16 v[116:119], v[72:75], v[68:71], v[116:119]
s_mov_b64 exec, 1
ds_add_u32 v242, v243 offset:76
s_mov_b64 exec, -1
ds_read_b64 v[248:249], v240
v_mfma_f32_16x16x32_bf16 v[120:123], v[76:79], v[64:67], v[120:123]
ds_read_b64 v[250:251], v240 offset:128
ds_read_b64 v[192:193], v241 offset:0
v_mfma_f32_16x16x32_bf16 v[124:127], v[76:79], v[68:71], v[124:127]
ds_read_b64 v[196:197], v241 offset:512
v_mfma_f32_16x16x32_bf16 v[128:131], v[80:83], v[64:67], v[128:131]
ds_read_b64 v[200:201], v241 offset:1024
v_mfma_f32_16x16x32_bf16 v[132:135], v[80:83], v[68:71], v[132:135]
ds_read_b64 v[204:205], v241 offset:1536
v_mfma_f32_16x16x32_bf16 v[136:139], v[84:87], v[64:67], v[136:139]
ds_read_b64 v[208:209], v241 offset:2048
v_mfma_f32_16x16x32_bf16 v[140:143], v[84:87], v[68:71], v[140:143]
ds_read_b64 v[212:213], v241 offset:2560
v_mfma_f32_16x16x32_bf16 v[144:147], v[88:91], v[64:67], v[144:147]
ds_read_b64 v[216:217], v241 offset:3072
v_mfma_f32_16x16x32_bf16 v[148:151], v[88:91], v[68:71], v[148:151]
ds_read_b64 v[220:221], v241 offset:3584
v_mfma_f32_16x16x32_bf16 v[152:155], v[92:95], v[64:67], v[152:155]
s_waitcnt lgkmcnt(8)
v_mfma_f32_16x16x32_bf16 v[156:159], v[92:95], v[68:71], v[156:159]
v_cndmask_b32 v233, 0, v248, s[66:67]
v_mfma_f32_16x16x32_bf16 v[160:163], v[96:99], v[64:67], v[160:163]
v_cndmask_b32 v232, v233, v249, s[68:69]
v_mfma_f32_16x16x32_bf16 v[164:167], v[96:99], v[68:71], v[164:167]
v_cndmask_b32 v237, 0, v250, s[66:67]
v_mfma_f32_16x16x32_bf16 v[168:171], v[100:103], v[64:67], v[168:171]
v_cndmask_b32 v236, v237, v251, s[68:69]
v_mfma_f32_16x16x32_bf16 v[172:175], v[100:103], v[68:71], v[172:175]
s_waitcnt lgkmcnt(0)
v_mfma_f32_16x16x32_bf16 v[112:115], v[192:195], v[232:235], v[112:115]
v_mfma_f32_16x16x32_bf16 v[116:119], v[192:195], v[236:239], v[116:119]
v_mfma_f32_16x16x32_bf16 v[120:123], v[196:199], v[232:235], v[120:123]
v_mfma_f32_16x16x32_bf16 v[124:127], v[196:199], v[236:239], v[124:127]
v_mfma_f32_16x16x32_bf16 v[128:131], v[200:203], v[232:235], v[128:131]
v_mfma_f32_16x16x32_bf16 v[132:135], v[200:203], v[236:239], v[132:135]
v_mfma_f32_16x16x32_bf16 v[136:139], v[204:207], v[232:235], v[136:139]
v_mfma_f32_16x16x32_bf16 v[140:143], v[204:207], v[236:239], v[140:143]
v_mfma_f32_16x16x32_bf16 v[144:147], v[208:211], v[232:235], v[144:147]
v_mfma_f32_16x16x32_bf16 v[148:151], v[208:211], v[236:239], v[148:151]
v_mfma_f32_16x16x32_bf16 v[152:155], v[212:215], v[232:235], v[152:155]
v_mfma_f32_16x16x32_bf16 v[156:159], v[212:215], v[236:239], v[156:159]
v_mfma_f32_16x16x32_bf16 v[160:163], v[216:219], v[232:235], v[160:163]
v_mfma_f32_16x16x32_bf16 v[164:167], v[216:219], v[236:239], v[164:167]
v_mfma_f32_16x16x32_bf16 v[168:171], v[220:223], v[232:235], v[168:171]
v_mfma_f32_16x16x32_bf16 v[172:175], v[220:223], v[236:239], v[172:175]
v_lshlrev_b32 v11, 4, v0
s_lshl_b32 s17, s26, 2
s_add_u32 s17, s17, s16
s_mul_i32 s17, s17, 110592
s_add_u32 s17, s17, 4194304
s_cmp_lt_u32 s28, 42
s_cselect_b32 s27, 12, -30
s_cmp_lt_u32 s28, 32
s_cselect_b32 s27, -20, s27
s_cmp_lt_u32 s28, 20
s_cselect_b32 s27, 24, s27
s_lshl_b32 s27, s27, 11
s_add_u32 s17, s17, s27
s_lshl_b32 s18, s30, 11
s_add_u32 s18, s18, s17
s_lshl_b32 s19, s28, 11
s_add_u32 s17, s17, s19
s_add_u32 s19, s17, 4096
.p2align 3
v_max_f32 v84, 0, v112
v_max_f32 v85, 0, v113
v_max_f32 v86, 0, v114
v_max_f32 v87, 0, v115
v_pk_mul_f32 v[84:85], v[84:85], v[112:113]
v_max_f32 v88, 0, v120
v_max_f32 v89, 0, v121
v_pk_mul_f32 v[86:87], v[86:87], v[114:115]
v_cvt_pk_bf16_f32 v68, v84, v85
v_max_f32 v90, 0, v122
v_max_f32 v91, 0, v123
v_pk_mul_f32 v[88:89], v[88:89], v[120:121]
v_cvt_pk_bf16_f32 v69, v86, v87
v_max_f32 v84, 0, v116
v_max_f32 v85, 0, v117
v_pk_mul_f32 v[90:91], v[90:91], v[122:123]
v_cvt_pk_bf16_f32 v70, v88, v89
v_max_f32 v86, 0, v118
v_max_f32 v87, 0, v119
v_pk_mul_f32 v[84:85], v[84:85], v[116:117]
v_cvt_pk_bf16_f32 v71, v90, v91
v_max_f32 v88, 0, v124
v_max_f32 v89, 0, v125
v_pk_mul_f32 v[86:87], v[86:87], v[118:119]
v_cvt_pk_bf16_f32 v72, v84, v85
v_max_f32 v90, 0, v126
v_max_f32 v91, 0, v127
v_pk_mul_f32 v[88:89], v[88:89], v[124:125]
v_cvt_pk_bf16_f32 v73, v86, v87
v_pk_mul_f32 v[90:91], v[90:91], v[126:127]
v_cvt_pk_bf16_f32 v74, v88, v89
v_cvt_pk_bf16_f32 v75, v90, v91
buffer_store_dwordx4 v[68:71], v11, s[44:47], s17 offen offset:0 sc1
buffer_store_dwordx4 v[72:75], v11, s[44:47], s17 offen offset:1024 sc1
v_max_f32 v84, 0, v128
v_max_f32 v85, 0, v129
v_max_f32 v86, 0, v130
v_max_f32 v87, 0, v131
v_pk_mul_f32 v[84:85], v[84:85], v[128:129]
v_max_f32 v88, 0, v136
v_max_f32 v89, 0, v137
v_pk_mul_f32 v[86:87], v[86:87], v[130:131]
v_cvt_pk_bf16_f32 v76, v84, v85
v_max_f32 v90, 0, v138
v_max_f32 v91, 0, v139
v_pk_mul_f32 v[88:89], v[88:89], v[136:137]
v_cvt_pk_bf16_f32 v77, v86, v87
v_max_f32 v84, 0, v132
v_max_f32 v85, 0, v133
v_pk_mul_f32 v[90:91], v[90:91], v[138:139]
v_cvt_pk_bf16_f32 v78, v88, v89
v_max_f32 v86, 0, v134
v_max_f32 v87, 0, v135
v_pk_mul_f32 v[84:85], v[84:85], v[132:133]
v_cvt_pk_bf16_f32 v79, v90, v91
v_max_f32 v88, 0, v140
v_max_f32 v89, 0, v141
v_pk_mul_f32 v[86:87], v[86:87], v[134:135]
v_cvt_pk_bf16_f32 v80, v84, v85
v_max_f32 v90, 0, v142
v_max_f32 v91, 0, v143
v_pk_mul_f32 v[88:89], v[88:89], v[140:141]
v_cvt_pk_bf16_f32 v81, v86, v87
v_pk_mul_f32 v[90:91], v[90:91], v[142:143]
v_cvt_pk_bf16_f32 v82, v88, v89
v_cvt_pk_bf16_f32 v83, v90, v91
buffer_store_dwordx4 v[76:79], v11, s[44:47], s17 offen offset:2048 sc1
buffer_store_dwordx4 v[80:83], v11, s[44:47], s17 offen offset:3072 sc1
v_max_f32 v84, 0, v144
v_max_f32 v85, 0, v145
v_max_f32 v86, 0, v146
v_max_f32 v87, 0, v147
v_pk_mul_f32 v[84:85], v[84:85], v[144:145]
v_max_f32 v88, 0, v152
v_max_f32 v89, 0, v153
v_pk_mul_f32 v[86:87], v[86:87], v[146:147]
v_cvt_pk_bf16_f32 v68, v84, v85
v_max_f32 v90, 0, v154
v_max_f32 v91, 0, v155
v_pk_mul_f32 v[88:89], v[88:89], v[152:153]
v_cvt_pk_bf16_f32 v69, v86, v87
v_max_f32 v84, 0, v148
v_max_f32 v85, 0, v149
v_pk_mul_f32 v[90:91], v[90:91], v[154:155]
v_cvt_pk_bf16_f32 v70, v88, v89
v_max_f32 v86, 0, v150
v_max_f32 v87, 0, v151
v_pk_mul_f32 v[84:85], v[84:85], v[148:149]
v_cvt_pk_bf16_f32 v71, v90, v91
v_max_f32 v88, 0, v156
v_max_f32 v89, 0, v157
v_pk_mul_f32 v[86:87], v[86:87], v[150:151]
v_cvt_pk_bf16_f32 v72, v84, v85
v_max_f32 v90, 0, v158
v_max_f32 v91, 0, v159
v_pk_mul_f32 v[88:89], v[88:89], v[156:157]
v_cvt_pk_bf16_f32 v73, v86, v87
v_pk_mul_f32 v[90:91], v[90:91], v[158:159]
v_cvt_pk_bf16_f32 v74, v88, v89
v_cvt_pk_bf16_f32 v75, v90, v91
buffer_store_dwordx4 v[68:71], v11, s[44:47], s19 offen offset:0 sc1
buffer_store_dwordx4 v[72:75], v11, s[44:47], s19 offen offset:1024 sc1
v_max_f32 v84, 0, v160
v_max_f32 v85, 0, v161
v_max_f32 v86, 0, v162
v_max_f32 v87, 0, v163
v_pk_mul_f32 v[84:85], v[84:85], v[160:161]
v_max_f32 v88, 0, v168
v_max_f32 v89, 0, v169
v_pk_mul_f32 v[86:87], v[86:87], v[162:163]
v_cvt_pk_bf16_f32 v76, v84, v85
v_max_f32 v90, 0, v170
v_max_f32 v91, 0, v171
v_pk_mul_f32 v[88:89], v[88:89], v[168:169]
v_cvt_pk_bf16_f32 v77, v86, v87
v_max_f32 v84, 0, v164
v_max_f32 v85, 0, v165
v_pk_mul_f32 v[90:91], v[90:91], v[170:171]
v_cvt_pk_bf16_f32 v78, v88, v89
v_max_f32 v86, 0, v166
v_max_f32 v87, 0, v167
v_pk_mul_f32 v[84:85], v[84:85], v[164:165]
v_cvt_pk_bf16_f32 v79, v90, v91
v_max_f32 v88, 0, v172
v_max_f32 v89, 0, v173
v_pk_mul_f32 v[86:87], v[86:87], v[166:167]
v_cvt_pk_bf16_f32 v80, v84, v85
v_max_f32 v90, 0, v174
v_max_f32 v91, 0, v175
v_pk_mul_f32 v[88:89], v[88:89], v[172:173]
v_cvt_pk_bf16_f32 v81, v86, v87
v_pk_mul_f32 v[90:91], v[90:91], v[174:175]
v_cvt_pk_bf16_f32 v82, v88, v89
v_cvt_pk_bf16_f32 v83, v90, v91
buffer_store_dwordx4 v[76:79], v11, s[44:47], s19 offen offset:2048 sc1
buffer_store_dwordx4 v[80:83], v11, s[44:47], s19 offen offset:3072 sc1
v_mov_b32 v10, 162816
v_mov_b32 v13, 1
s_mov_b64 exec, 1
ds_add_u32 v10, v13 offset:8
s_mov_b64 exec, -1
L_g_issued:
s_lshl_b32 s18, s16, 3
s_lshr_b32 s17, 0x2f282018, s18
s_and_b32 s57, s17, 0xff
s_mul_i32 s48, s16, 6
s_sub_u32 s57, s57, s48
s_sub_u32 s57, s57, 6
s_lshl_b32 s58, s57, 11
s_mul_i32 s57, s57, 40960
s_mul_i32 s49, s48, 40960
s_mul_i32 s17, s15, 5120
s_add_u32 s49, s49, s17
s_add_u32 s49, s49, 1048576
s_add_u32 s51, s49, 4096
s_lshl_b32 s19, s48, 11
s_lshl_b32 s17, s31, 10
s_add_u32 s19, s19, s17
s_add_u32 s19, s19, 4194304
s_lshl_b32 s18, s20, 2
v_lshlrev_b32 v1, 4, v0
s_add_u32 s17, s16, 0
s_and_b32 s17, s17, 3
s_add_u32 s17, s17, s18
s_mul_i32 s17, s17, 110592
s_add_u32 s52, s17, s19
s_add_u32 s17, s16, 1
s_and_b32 s17, s17, 3
s_add_u32 s17, s17, s18
s_mul_i32 s17, s17, 110592
s_add_u32 s53, s17, s19
s_add_u32 s17, s16, 2
s_and_b32 s17, s17, 3
s_add_u32 s17, s17, s18
s_mul_i32 s17, s17, 110592
s_add_u32 s54, s17, s19
s_add_u32 s17, s16, 3
s_and_b32 s17, s17, 3
s_add_u32 s17, s17, s18
s_mul_i32 s17, s17, 110592
s_add_u32 s55, s17, s19
s_mul_i32 s48, s16, 35840
s_cmp_ge_u32 s16, 2
s_cselect_b32 s27, 2048, 0
s_add_u32 s48, s48, s27
s_cmp_eq_u32 s16, 3
s_cselect_b32 s48, 104448, s48
v_mov_b32 v2, s14
v_lshlrev_b32 v3, 2, v0
s_lshl_b32 s56, s26, 11
s_add_u32 s56, s56, 294912
s_lshl_b32 s50, s29, 7
s_add_u32 s50, s50, s56
v_mov_b32 v4, 1
s_waitcnt vmcnt(0)
s_mov_b64 exec, 1
ds_add_rtn_u32 v4, v10, v4 offset:0
s_waitcnt lgkmcnt(0)
v_readfirstlane_b32 s17, v4
s_cmp_eq_u32 s17, 3
s_cbranch_scc0 L_g_noflag
s_mov_b32 exec_lo, -1
buffer_store_dword v2, v3, s[44:47], s50 offen sc1
ds_write_b32 v10, v10 offset:64
L_g_noflag:
s_mov_b64 exec, -1
v_add_u32 v2, s48, v1
v_mov_b32 v3, v10
s_mov_b32 s19, 0
L_sp53:
ds_read_b32 v4, v3 offset:64
s_waitcnt lgkmcnt(0)
v_readfirstlane_b32 s27, v4
s_add_u32 s19, s19, 1
s_cmp_gt_u32 s19, 200000
s_cbranch_scc1 L_sp53d
s_cmp_ge_u32 s27, 1
s_cbranch_scc1 L_sp53d
s_sleep 1
s_branch L_sp53
L_sp53d:
s_cmp_eq_u32 s34, 1
s_cbranch_scc0 L_g_fwok
s_mov_b32 s19, 0
L_sp54:
ds_read_b32 v4, v3 offset:12
s_waitcnt lgkmcnt(0)
v_readfirstlane_b32 s27, v4
s_add_u32 s19, s19, 1
s_cmp_gt_u32 s19, 200000
s_cbranch_scc1 L_sp54d
s_cmp_ge_u32 s27, 1
s_cbranch_scc1 L_sp54d
s_sleep 1
s_branch L_sp54
L_sp54d:
L_g_fwok:
buffer_load_dwordx4 v[36:39], v1, s[44:47], s49 offen offset:0 sc1
buffer_load_dwordx4 v[40:43], v1, s[44:47], s49 offen offset:1024 sc1
buffer_load_dwordx4 v[44:47], v1, s[44:47], s49 offen offset:2048 sc1
buffer_load_dwordx4 v[48:51], v1, s[44:47], s49 offen offset:3072 sc1
buffer_load_dwordx4 v[52:55], v1, s[44:47], s51 offen offset:0 sc1
s_add_u32 s49, s49, 40960
s_add_u32 s51, s51, 40960
buffer_load_dwordx4 v[56:59], v1, s[44:47], s49 offen offset:0 sc1
buffer_load_dwordx4 v[60:63], v1, s[44:47], s49 offen offset:1024 sc1
buffer_load_dwordx4 v[64:67], v1, s[44:47], s49 offen offset:2048 sc1
buffer_load_dwordx4 v[68:71], v1, s[44:47], s49 offen offset:3072 sc1
buffer_load_dwordx4 v[72:75], v1, s[44:47], s51 offen offset:0 sc1
s_add_u32 s49, s49, 40960
s_add_u32 s51, s51, 40960
buffer_load_dwordx4 v[76:79], v1, s[44:47], s49 offen offset:0 sc1
buffer_load_dwordx4 v[80:83], v1, s[44:47], s49 offen offset:1024 sc1
buffer_load_dwordx4 v[84:87], v1, s[44:47], s49 offen offset:2048 sc1
buffer_load_dwordx4 v[88:91], v1, s[44:47], s49 offen offset:3072 sc1
buffer_load_dwordx4 v[92:95], v1, s[44:47], s51 offen offset:0 sc1
s_add_u32 s49, s49, 40960
s_add_u32 s51, s51, 40960
v_mov_b32 v4, 1
s_mov_b64 exec, 1
ds_add_u32 v3, v4 offset:68
s_mov_b64 exec, -1
buffer_load_dwordx4 v[96:99], v1, s[44:47], s49 offen offset:0 sc1
buffer_load_dwordx4 v[100:103], v1, s[44:47], s49 offen offset:1024 sc1
buffer_load_dwordx4 v[104:107], v1, s[44:47], s49 offen offset:2048 sc1
buffer_load_dwordx4 v[108:111], v1, s[44:47], s49 offen offset:3072 sc1
buffer_load_dwordx4 v[112:115], v1, s[44:47], s51 offen offset:0 sc1
s_add_u32 s49, s49, 40960
s_add_u32 s51, s51, 40960
buffer_load_dwordx4 v[116:119], v1, s[44:47], s49 offen offset:0 sc1
buffer_load_dwordx4 v[120:123], v1, s[44:47], s49 offen offset:1024 sc1
buffer_load_dwordx4 v[124:127], v1, s[44:47], s49 offen offset:2048 sc1
buffer_load_dwordx4 v[128:131], v1, s[44:47], s49 offen offset:3072 sc1
buffer_load_dwordx4 v[132:135], v1, s[44:47], s51 offen offset:0 sc1
s_add_u32 s49, s49, 40960
s_add_u32 s51, s51, 40960
s_mov_b32 s19, 0
L_sp55:
ds_read_b32 v4, v3 offset:20
s_waitcnt lgkmcnt(0)
v_readfirstlane_b32 s27, v4
s_add_u32 s19, s19, 1
s_cmp_gt_u32 s19, 200000
s_cbranch_scc1 L_sp55d
s_cmp_ge_u32 s27, 1
s_cbranch_scc1 L_sp55d
s_sleep 1
s_branch L_sp55
L_sp55d:
buffer_load_dwordx4 v[4:7], v1, s[44:47], s52 offen offset:0 sc1
buffer_load_dwordx4 v[8:11], v1, s[44:47], s53 offen offset:0 sc1
buffer_load_dwordx4 v[12:15], v1, s[44:47], s54 offen offset:0 sc1
buffer_load_dwordx4 v[16:19], v1, s[44:47], s55 offen offset:0 sc1
buffer_load_dwordx4 v[20:23], v1, s[44:47], s52 offen offset:2048 sc1
buffer_load_dwordx4 v[24:27], v1, s[44:47], s53 offen offset:2048 sc1
buffer_load_dwordx4 v[28:31], v1, s[44:47], s54 offen offset:2048 sc1
buffer_load_dwordx4 v[32:35], v1, s[44:47], s55 offen offset:2048 sc1
s_add_u32 s52, s52, 4096
s_add_u32 s53, s53, 4096
s_add_u32 s54, s54, 4096
s_add_u32 s55, s55, 4096
buffer_load_dwordx4 v[136:139], v1, s[44:47], s52 offen offset:0 sc1
buffer_load_dwordx4 v[140:143], v1, s[44:47], s53 offen offset:0 sc1
buffer_load_dwordx4 v[144:147], v1, s[44:47], s54 offen offset:0 sc1
buffer_load_dwordx4 v[148:151], v1, s[44:47], s55 offen offset:0 sc1
buffer_load_dwordx4 v[156:159], v1, s[44:47], s52 offen offset:2048 sc1
buffer_load_dwordx4 v[160:163], v1, s[44:47], s53 offen offset:2048 sc1
buffer_load_dwordx4 v[164:167], v1, s[44:47], s54 offen offset:2048 sc1
buffer_load_dwordx4 v[168:171], v1, s[44:47], s55 offen offset:2048 sc1
s_add_u32 s52, s52, 4096
s_add_u32 s53, s53, 4096
s_add_u32 s54, s54, 4096
s_add_u32 s55, s55, 4096
s_waitcnt vmcnt(12)
.p2align 3
v_mfma_f32_16x16x32_bf16 v[176:179], v[36:39], v[4:7], 0
v_mfma_f32_16x16x32_bf16 v[180:183], v[40:43], v[4:7], 0
v_mfma_f32_16x16x32_bf16 v[184:187], v[44:47], v[4:7], 0
v_mfma_f32_16x16x32_bf16 v[188:191], v[48:51], v[4:7], 0
v_mfma_f32_16x16x32_bf16 v[192:195], v[52:55], v[4:7], 0
v_mfma_f32_16x16x32_bf16 v[196:199], v[36:39], v[8:11], 0
v_mfma_f32_16x16x32_bf16 v[200:203], v[40:43], v[8:11], 0
v_mfma_f32_16x16x32_bf16 v[204:207], v[44:47], v[8:11], 0
v_mfma_f32_16x16x32_bf16 v[208:211], v[48:51], v[8:11], 0
v_mfma_f32_16x16x32_bf16 v[212:215], v[52:55], v[8:11], 0
v_mfma_f32_16x16x32_bf16 v[216:219], v[36:39], v[12:15], 0
v_mfma_f32_16x16x32_bf16 v[220:223], v[40:43], v[12:15], 0
v_mfma_f32_16x16x32_bf16 v[224:227], v[44:47], v[12:15], 0
v_mfma_f32_16x16x32_bf16 v[228:231], v[48:51], v[12:15], 0
v_mfma_f32_16x16x32_bf16 v[232:235], v[52:55], v[12:15], 0
v_mfma_f32_16x16x32_bf16 v[236:239], v[36:39], v[16:19], 0
v_mfma_f32_16x16x32_bf16 v[240:243], v[40:43], v[16:19], 0
v_mfma_f32_16x16x32_bf16 v[244:247], v[44:47], v[16:19], 0
v_mfma_f32_16x16x32_bf16 v[248:251], v[48:51], v[16:19], 0
v_mfma_f32_16x16x32_bf16 v[252:255], v[52:55], v[16:19], 0
s_waitcnt vmcnt(8)
.p2align 3
v_mfma_f32_16x16x32_bf16 v[176:179], v[56:59], v[20:23], v[176:179]
v_mfma_f32_16x16x32_bf16 v[180:183], v[60:63], v[20:23], v[180:183]
buffer_load_dwordx4 v[36:39], v1, s[44:47], s49 offen offset:0 sc1
v_mfma_f32_16x16x32_bf16 v[184:187], v[64:67], v[20:23], v[184:187]
v_mfma_f32_16x16x32_bf16 v[188:191], v[68:71], v[20:23], v[188:191]
buffer_load_dwordx4 v[40:43], v1, s[44:47], s49 offen offset:1024 sc1
v_mfma_f32_16x16x32_bf16 v[192:195], v[72:75], v[20:23], v[192:195]
v_mfma_f32_16x16x32_bf16 v[196:199], v[56:59], v[24:27], v[196:199]
buffer_load_dwordx4 v[44:47], v1, s[44:47], s49 offen offset:2048 sc1
v_mfma_f32_16x16x32_bf16 v[200:203], v[60:63], v[24:27], v[200:203]
v_mfma_f32_16x16x32_bf16 v[204:207], v[64:67], v[24:27], v[204:207]
buffer_load_dwordx4 v[48:51], v1, s[44:47], s49 offen offset:3072 sc1
v_mfma_f32_16x16x32_bf16 v[208:211], v[68:71], v[24:27], v[208:211]
v_mfma_f32_16x16x32_bf16 v[212:215], v[72:75], v[24:27], v[212:215]
buffer_load_dwordx4 v[52:55], v1, s[44:47], s51 offen offset:0 sc1
s_add_u32 s49, s49, 40960
s_add_u32 s51, s51, 40960
s_add_u32 s49, s49, s57
s_add_u32 s51, s51, s57
v_mfma_f32_16x16x32_bf16 v[216:219], v[56:59], v[28:31], v[216:219]
v_mfma_f32_16x16x32_bf16 v[220:223], v[60:63], v[28:31], v[220:223]
buffer_load_dwordx4 v[4:7], v1, s[44:47], s52 offen offset:0 sc1
v_mfma_f32_16x16x32_bf16 v[224:227], v[64:67], v[28:31], v[224:227]
v_mfma_f32_16x16x32_bf16 v[228:231], v[68:71], v[28:31], v[228:231]
buffer_load_dwordx4 v[8:11], v1, s[44:47], s53 offen offset:0 sc1
v_mfma_f32_16x16x32_bf16 v[232:235], v[72:75], v[28:31], v[232:235]
v_mfma_f32_16x16x32_bf16 v[236:239], v[56:59], v[32:35], v[236:239]
buffer_load_dwordx4 v[12:15], v1, s[44:47], s54 offen offset:0 sc1
v_mfma_f32_16x16x32_bf16 v[240:243], v[60:63], v[32:35], v[240:243]
v_mfma_f32_16x16x32_bf16 v[244:247], v[64:67], v[32:35], v[244:247]
buffer_load_dwordx4 v[16:19], v1, s[44:47], s55 offen offset:0 sc1
v_mfma_f32_16x16x32_bf16 v[248:251], v[68:71], v[32:35], v[248:251]
v_mfma_f32_16x16x32_bf16 v[252:255], v[72:75], v[32:35], v[252:255]
s_waitcnt vmcnt(13)
.p2align 3
v_mfma_f32_16x16x32_bf16 v[176:179], v[76:79], v[136:139], v[176:179]
v_mfma_f32_16x16x32_bf16 v[180:183], v[80:83], v[136:139], v[180:183]
buffer_load_dwordx4 v[56:59], v1, s[44:47], s49 offen offset:0 sc1
v_mfma_f32_16x16x32_bf16 v[184:187], v[84:87], v[136:139], v[184:187]
v_mfma_f32_16x16x32_bf16 v[188:191], v[88:91], v[136:139], v[188:191]
buffer_load_dwordx4 v[60:63], v1, s[44:47], s49 offen offset:1024 sc1
v_mfma_f32_16x16x32_bf16 v[192:195], v[92:95], v[136:139], v[192:195]
v_mfma_f32_16x16x32_bf16 v[196:199], v[76:79], v[140:143], v[196:199]
buffer_load_dwordx4 v[64:67], v1, s[44:47], s49 offen offset:2048 sc1
v_mfma_f32_16x16x32_bf16 v[200:203], v[80:83], v[140:143], v[200:203]
v_mfma_f32_16x16x32_bf16 v[204:207], v[84:87], v[140:143], v[204:207]
buffer_load_dwordx4 v[68:71], v1, s[44:47], s49 offen offset:3072 sc1
v_mfma_f32_16x16x32_bf16 v[208:211], v[88:91], v[140:143], v[208:211]
v_mfma_f32_16x16x32_bf16 v[212:215], v[92:95], v[140:143], v[212:215]
buffer_load_dwordx4 v[72:75], v1, s[44:47], s51 offen offset:0 sc1
s_add_u32 s49, s49, 40960
s_add_u32 s51, s51, 40960
v_mfma_f32_16x16x32_bf16 v[216:219], v[76:79], v[144:147], v[216:219]
v_mfma_f32_16x16x32_bf16 v[220:223], v[80:83], v[144:147], v[220:223]
buffer_load_dwordx4 v[20:23], v1, s[44:47], s52 offen offset:2048 sc1
v_mfma_f32_16x16x32_bf16 v[224:227], v[84:87], v[144:147], v[224:227]
v_mfma_f32_16x16x32_bf16 v[228:231], v[88:91], v[144:147], v[228:231]
buffer_load_dwordx4 v[24:27], v1, s[44:47], s53 offen offset:2048 sc1
v_mfma_f32_16x16x32_bf16 v[232:235], v[92:95], v[144:147], v[232:235]
v_mfma_f32_16x16x32_bf16 v[236:239], v[76:79], v[148:151], v[236:239]
buffer_load_dwordx4 v[28:31], v1, s[44:47], s54 offen offset:2048 sc1
v_mfma_f32_16x16x32_bf16 v[240:243], v[80:83], v[148:151], v[240:243]
v_mfma_f32_16x16x32_bf16 v[244:247], v[84:87], v[148:151], v[244:247]
buffer_load_dwordx4 v[32:35], v1, s[44:47], s55 offen offset:2048 sc1
s_add_u32 s52, s52, 4096
s_add_u32 s53, s53, 4096
s_add_u32 s54, s54, 4096
s_add_u32 s55, s55, 4096
s_add_u32 s52, s52, s58
s_add_u32 s53, s53, s58
s_add_u32 s54, s54, s58
s_add_u32 s55, s55, s58
v_mfma_f32_16x16x32_bf16 v[248:251], v[88:91], v[148:151], v[248:251]
v_mfma_f32_16x16x32_bf16 v[252:255], v[92:95], v[148:151], v[252:255]
s_waitcnt vmcnt(18)
.p2align 3
v_mfma_f32_16x16x32_bf16 v[176:179], v[96:99], v[156:159], v[176:179]
v_mfma_f32_16x16x32_bf16 v[180:183], v[100:103], v[156:159], v[180:183]
s_mov_b32 s19, 0
L_sp56:
ds_read_b32 v0, v3 offset:72
s_waitcnt lgkmcnt(0)
v_readfirstlane_b32 s27, v0

s_add_u32 s19, s19, 1
s_cmp_gt_u32 s19, 200000
s_cbranch_scc1 L_sp56d
s_cmp_ge_u32 s27, 1
s_cbranch_scc0 L_sp56
L_sp56d:
v_lshrrev_b32 v0, 4, v1
.p2align 3
buffer_load_dwordx4 v[76:79], v1, s[44:47], s52 offen offset:0 sc1
v_mfma_f32_16x16x32_bf16 v[184:187], v[104:107], v[156:159], v[184:187]
v_mfma_f32_16x16x32_bf16 v[188:191], v[108:111], v[156:159], v[188:191]
v_mfma_f32_16x16x32_bf16 v[192:195], v[112:115], v[156:159], v[192:195]
v_mfma_f32_16x16x32_bf16 v[196:199], v[96:99], v[160:163], v[196:199]
buffer_load_dwordx4 v[80:83], v1, s[44:47], s53 offen offset:0 sc1
v_mfma_f32_16x16x32_bf16 v[200:203], v[100:103], v[160:163], v[200:203]
v_mfma_f32_16x16x32_bf16 v[204:207], v[104:107], v[160:163], v[204:207]
v_mfma_f32_16x16x32_bf16 v[208:211], v[108:111], v[160:163], v[208:211]
v_mfma_f32_16x16x32_bf16 v[212:215], v[112:115], v[160:163], v[212:215]
v_mfma_f32_16x16x32_bf16 v[216:219], v[96:99], v[164:167], v[216:219]
buffer_load_dwordx4 v[84:87], v1, s[44:47], s54 offen offset:0 sc1
v_mfma_f32_16x16x32_bf16 v[220:223], v[100:103], v[164:167], v[220:223]
v_mfma_f32_16x16x32_bf16 v[224:227], v[104:107], v[164:167], v[224:227]
v_mfma_f32_16x16x32_bf16 v[228:231], v[108:111], v[164:167], v[228:231]
v_mfma_f32_16x16x32_bf16 v[232:235], v[112:115], v[164:167], v[232:235]
v_mfma_f32_16x16x32_bf16 v[236:239], v[96:99], v[168:171], v[236:239]
buffer_load_dwordx4 v[88:91], v1, s[44:47], s55 offen offset:0 sc1
v_mfma_f32_16x16x32_bf16 v[240:243], v[100:103], v[168:171], v[240:243]
v_mfma_f32_16x16x32_bf16 v[244:247], v[104:107], v[168:171], v[244:247]
v_mfma_f32_16x16x32_bf16 v[248:251], v[108:111], v[168:171], v[248:251]
v_mfma_f32_16x16x32_bf16 v[252:255], v[112:115], v[168:171], v[252:255]
s_waitcnt vmcnt(13)
.p2align 3
v_mfma_f32_16x16x32_bf16 v[176:179], v[116:119], v[4:7], v[176:179]
v_mfma_f32_16x16x32_bf16 v[180:183], v[120:123], v[4:7], v[180:183]
buffer_load_dwordx4 v[136:139], v1, s[44:47], s52 offen offset:2048 sc1
v_mfma_f32_16x16x32_bf16 v[184:187], v[124:127], v[4:7], v[184:187]
v_mfma_f32_16x16x32_bf16 v[188:191], v[128:131], v[4:7], v[188:191]
v_mfma_f32_16x16x32_bf16 v[192:195], v[132:135], v[4:7], v[192:195]
v_mfma_f32_16x16x32_bf16 v[196:199], v[116:119], v[8:11], v[196:199]
buffer_load_dwordx4 v[140:143], v1, s[44:47], s53 offen offset:2048 sc1
v_mfma_f32_16x16x32_bf16 v[200:203], v[120:123], v[8:11], v[200:203]
v_mfma_f32_16x16x32_bf16 v[204:207], v[124:127], v[8:11], v[204:207]
v_mfma_f32_16x16x32_bf16 v[208:211], v[128:131], v[8:11], v[208:211]
v_mfma_f32_16x16x32_bf16 v[212:215], v[132:135], v[8:11], v[212:215]
v_mfma_f32_16x16x32_bf16 v[216:219], v[116:119], v[12:15], v[216:219]
buffer_load_dwordx4 v[144:147], v1, s[44:47], s54 offen offset:2048 sc1
v_mfma_f32_16x16x32_bf16 v[220:223], v[120:123], v[12:15], v[220:223]
v_mfma_f32_16x16x32_bf16 v[224:227], v[124:127], v[12:15], v[224:227]
v_mfma_f32_16x16x32_bf16 v[228:231], v[128:131], v[12:15], v[228:231]
v_mfma_f32_16x16x32_bf16 v[232:235], v[132:135], v[12:15], v[232:235]
v_mfma_f32_16x16x32_bf16 v[236:239], v[116:119], v[16:19], v[236:239]
buffer_load_dwordx4 v[148:151], v1, s[44:47], s55 offen offset:2048 sc1
s_add_u32 s52, s52, 4096
s_add_u32 s53, s53, 4096
s_add_u32 s54, s54, 4096
s_add_u32 s55, s55, 4096
v_mfma_f32_16x16x32_bf16 v[240:243], v[120:123], v[16:19], v[240:243]
v_mfma_f32_16x16x32_bf16 v[244:247], v[124:127], v[16:19], v[244:247]
v_mfma_f32_16x16x32_bf16 v[248:251], v[128:131], v[16:19], v[248:251]
v_mfma_f32_16x16x32_bf16 v[252:255], v[132:135], v[16:19], v[252:255]
s_waitcnt vmcnt(8)
.p2align 3
v_mfma_f32_16x16x32_bf16 v[176:179], v[36:39], v[20:23], v[176:179]
v_mfma_f32_16x16x32_bf16 v[180:183], v[40:43], v[20:23], v[180:183]
buffer_load_dwordx4 v[4:7], v1, s[44:47], s52 offen offset:0 sc1
v_mfma_f32_16x16x32_bf16 v[184:187], v[44:47], v[20:23], v[184:187]
v_mfma_f32_16x16x32_bf16 v[188:191], v[48:51], v[20:23], v[188:191]
v_mfma_f32_16x16x32_bf16 v[192:195], v[52:55], v[20:23], v[192:195]
v_mfma_f32_16x16x32_bf16 v[196:199], v[36:39], v[24:27], v[196:199]
buffer_load_dwordx4 v[8:11], v1, s[44:47], s53 offen offset:0 sc1
v_mfma_f32_16x16x32_bf16 v[200:203], v[40:43], v[24:27], v[200:203]
v_mfma_f32_16x16x32_bf16 v[204:207], v[44:47], v[24:27], v[204:207]
v_mfma_f32_16x16x32_bf16 v[208:211], v[48:51], v[24:27], v[208:211]
v_mfma_f32_16x16x32_bf16 v[212:215], v[52:55], v[24:27], v[212:215]
v_mfma_f32_16x16x32_bf16 v[216:219], v[36:39], v[28:31], v[216:219]
buffer_load_dwordx4 v[12:15], v1, s[44:47], s54 offen offset:0 sc1
v_mfma_f32_16x16x32_bf16 v[220:223], v[40:43], v[28:31], v[220:223]
v_mfma_f32_16x16x32_bf16 v[224:227], v[44:47], v[28:31], v[224:227]
v_mfma_f32_16x16x32_bf16 v[228:231], v[48:51], v[28:31], v[228:231]
v_mfma_f32_16x16x32_bf16 v[232:235], v[52:55], v[28:31], v[232:235]
v_mfma_f32_16x16x32_bf16 v[236:239], v[36:39], v[32:35], v[236:239]
buffer_load_dwordx4 v[16:19], v1, s[44:47], s55 offen offset:0 sc1
v_mfma_f32_16x16x32_bf16 v[240:243], v[40:43], v[32:35], v[240:243]
v_mfma_f32_16x16x32_bf16 v[244:247], v[44:47], v[32:35], v[244:247]
v_mfma_f32_16x16x32_bf16 v[248:251], v[48:51], v[32:35], v[248:251]
v_mfma_f32_16x16x32_bf16 v[252:255], v[52:55], v[32:35], v[252:255]
s_waitcnt vmcnt(8)
.p2align 3
v_mfma_f32_16x16x32_bf16 v[176:179], v[56:59], v[76:79], v[176:179]
s_lshl_b32 s17, s16, 2
v_add_u32 v0, s17, v3
s_mov_b32 s19, 0
L_sp57:
ds_read_b32 v0, v0 offset:32
s_waitcnt lgkmcnt(0)
v_readfirstlane_b32 s27, v0
v_add_u32 v0, s17, v3
s_add_u32 s19, s19, 1
s_cmp_gt_u32 s19, 200000
s_cbranch_scc1 L_sp57d
s_cmp_ge_u32 s27, 1
s_cbranch_scc0 L_sp57
L_sp57d:
v_lshrrev_b32 v0, 4, v1
.p2align 3
v_mfma_f32_16x16x32_bf16 v[180:183], v[60:63], v[76:79], v[180:183]
buffer_load_dwordx4 v[20:23], v1, s[44:47], s52 offen offset:2048 sc1
v_mfma_f32_16x16x32_bf16 v[184:187], v[64:67], v[76:79], v[184:187]
ds_read_b128 v[96:99], v2 offset:0
v_mfma_f32_16x16x32_bf16 v[188:191], v[68:71], v[76:79], v[188:191]
v_mfma_f32_16x16x32_bf16 v[192:195], v[72:75], v[76:79], v[192:195]
ds_read_b128 v[100:103], v2 offset:1024
v_mfma_f32_16x16x32_bf16 v[196:199], v[56:59], v[80:83], v[196:199]
buffer_load_dwordx4 v[24:27], v1, s[44:47], s53 offen offset:2048 sc1
v_mfma_f32_16x16x32_bf16 v[200:203], v[60:63], v[80:83], v[200:203]
ds_read_b128 v[104:107], v2 offset:2048
v_mfma_f32_16x16x32_bf16 v[204:207], v[64:67], v[80:83], v[204:207]
v_mfma_f32_16x16x32_bf16 v[208:211], v[68:71], v[80:83], v[208:211]
ds_read_b128 v[108:111], v2 offset:3072
v_mfma_f32_16x16x32_bf16 v[212:215], v[72:75], v[80:83], v[212:215]
v_mfma_f32_16x16x32_bf16 v[216:219], v[56:59], v[84:87], v[216:219]
ds_read_b128 v[112:115], v2 offset:4096
buffer_load_dwordx4 v[28:31], v1, s[44:47], s54 offen offset:2048 sc1
v_mfma_f32_16x16x32_bf16 v[220:223], v[60:63], v[84:87], v[220:223]
v_mfma_f32_16x16x32_bf16 v[224:227], v[64:67], v[84:87], v[224:227]
v_mfma_f32_16x16x32_bf16 v[228:231], v[68:71], v[84:87], v[228:231]
v_mfma_f32_16x16x32_bf16 v[232:235], v[72:75], v[84:87], v[232:235]
v_mfma_f32_16x16x32_bf16 v[236:239], v[56:59], v[88:91], v[236:239]
buffer_load_dwordx4 v[32:35], v1, s[44:47], s55 offen offset:2048 sc1
s_add_u32 s52, s52, 4096
s_add_u32 s53, s53, 4096
s_add_u32 s54, s54, 4096
s_add_u32 s55, s55, 4096
v_mfma_f32_16x16x32_bf16 v[240:243], v[60:63], v[88:91], v[240:243]
v_mfma_f32_16x16x32_bf16 v[244:247], v[64:67], v[88:91], v[244:247]
v_mfma_f32_16x16x32_bf16 v[248:251], v[68:71], v[88:91], v[248:251]
v_mfma_f32_16x16x32_bf16 v[252:255], v[72:75], v[88:91], v[252:255]
s_waitcnt vmcnt(8) lgkmcnt(0)
.p2align 3
v_mfma_f32_16x16x32_bf16 v[176:179], v[96:99], v[136:139], v[176:179]
ds_read_b128 v[156:159], v2 offset:5120
v_mfma_f32_16x16x32_bf16 v[180:183], v[100:103], v[136:139], v[180:183]
buffer_load_dwordx4 v[116:119], v1, s[44:47], s52 offen offset:0 sc1
v_mfma_f32_16x16x32_bf16 v[184:187], v[104:107], v[136:139], v[184:187]
ds_read_b128 v[160:163], v2 offset:6144
v_mfma_f32_16x16x32_bf16 v[188:191], v[108:111], v[136:139], v[188:191]
v_mfma_f32_16x16x32_bf16 v[192:195], v[112:115], v[136:139], v[192:195]
ds_read_b128 v[164:167], v2 offset:7168
v_mfma_f32_16x16x32_bf16 v[196:199], v[96:99], v[140:143], v[196:199]
buffer_load_dwordx4 v[120:123], v1, s[44:47], s53 offen offset:0 sc1
v_mfma_f32_16x16x32_bf16 v[200:203], v[100:103], v[140:143], v[200:203]
ds_read_b128 v[168:171], v2 offset:8192
v_mfma_f32_16x16x32_bf16 v[204:207], v[104:107], v[140:143], v[204:207]
v_mfma_f32_16x16x32_bf16 v[208:211], v[108:111], v[140:143], v[208:211]
ds_read_b128 v[172:175], v2 offset:9216
v_mfma_f32_16x16x32_bf16 v[212:215], v[112:115], v[140:143], v[212:215]
v_mfma_f32_16x16x32_bf16 v[216:219], v[96:99], v[144:147], v[216:219]
buffer_load_dwordx4 v[124:127], v1, s[44:47], s54 offen offset:0 sc1
v_mfma_f32_16x16x32_bf16 v[220:223], v[100:103], v[144:147], v[220:223]
v_mfma_f32_16x16x32_bf16 v[224:227], v[104:107], v[144:147], v[224:227]
v_mfma_f32_16x16x32_bf16 v[228:231], v[108:111], v[144:147], v[228:231]
v_mfma_f32_16x16x32_bf16 v[232:235], v[112:115], v[144:147], v[232:235]
v_mfma_f32_16x16x32_bf16 v[236:239], v[96:99], v[148:151], v[236:239]
buffer_load_dwordx4 v[128:131], v1, s[44:47], s55 offen offset:0 sc1
v_mfma_f32_16x16x32_bf16 v[240:243], v[100:103], v[148:151], v[240:243]
v_mfma_f32_16x16x32_bf16 v[244:247], v[104:107], v[148:151], v[244:247]
v_mfma_f32_16x16x32_bf16 v[248:251], v[108:111], v[148:151], v[248:251]
v_mfma_f32_16x16x32_bf16 v[252:255], v[112:115], v[148:151], v[252:255]
s_waitcnt vmcnt(8) lgkmcnt(0)
.p2align 3
v_mfma_f32_16x16x32_bf16 v[176:179], v[156:159], v[4:7], v[176:179]
ds_read_b128 v[36:39], v2 offset:10240
v_mfma_f32_16x16x32_bf16 v[180:183], v[160:163], v[4:7], v[180:183]
buffer_load_dwordx4 v[56:59], v1, s[44:47], s52 offen offset:2048 sc1
v_mfma_f32_16x16x32_bf16 v[184:187], v[164:167], v[4:7], v[184:187]
ds_read_b128 v[40:43], v2 offset:11264
v_mfma_f32_16x16x32_bf16 v[188:191], v[168:171], v[4:7], v[188:191]
v_mfma_f32_16x16x32_bf16 v[192:195], v[172:175], v[4:7], v[192:195]
ds_read_b128 v[44:47], v2 offset:12288
v_mfma_f32_16x16x32_bf16 v[196:199], v[156:159], v[8:11], v[196:199]
buffer_load_dwordx4 v[60:63], v1, s[44:47], s53 offen offset:2048 sc1
v_mfma_f32_16x16x32_bf16 v[200:203], v[160:163], v[8:11], v[200:203]
ds_read_b128 v[48:51], v2 offset:13312
v_mfma_f32_16x16x32_bf16 v[204:207], v[164:167], v[8:11], v[204:207]
v_mfma_f32_16x16x32_bf16 v[208:211], v[168:171], v[8:11], v[208:211]
ds_read_b128 v[52:55], v2 offset:14336
v_mfma_f32_16x16x32_bf16 v[212:215], v[172:175], v[8:11], v[212:215]
v_mfma_f32_16x16x32_bf16 v[216:219], v[156:159], v[12:15], v[216:219]
buffer_load_dwordx4 v[64:67], v1, s[44:47], s54 offen offset:2048 sc1
v_mfma_f32_16x16x32_bf16 v[220:223], v[160:163], v[12:15], v[220:223]
v_mfma_f32_16x16x32_bf16 v[224:227], v[164:167], v[12:15], v[224:227]
v_mfma_f32_16x16x32_bf16 v[228:231], v[168:171], v[12:15], v[228:231]
v_mfma_f32_16x16x32_bf16 v[232:235], v[172:175], v[12:15], v[232:235]
v_mfma_f32_16x16x32_bf16 v[236:239], v[156:159], v[16:19], v[236:239]
buffer_load_dwordx4 v[68:71], v1, s[44:47], s55 offen offset:2048 sc1
s_add_u32 s52, s52, 4096
s_add_u32 s53, s53, 4096
s_add_u32 s54, s54, 4096
s_add_u32 s55, s55, 4096
v_mfma_f32_16x16x32_bf16 v[240:243], v[160:163], v[16:19], v[240:243]
v_mfma_f32_16x16x32_bf16 v[244:247], v[164:167], v[16:19], v[244:247]
v_mfma_f32_16x16x32_bf16 v[248:251], v[168:171], v[16:19], v[248:251]
v_mfma_f32_16x16x32_bf16 v[252:255], v[172:175], v[16:19], v[252:255]
s_waitcnt vmcnt(8) lgkmcnt(0)
.p2align 3
v_mfma_f32_16x16x32_bf16 v[176:179], v[36:39], v[20:23], v[176:179]
ds_read_b128 v[76:79], v2 offset:15360
v_mfma_f32_16x16x32_bf16 v[180:183], v[40:43], v[20:23], v[180:183]
buffer_load_dwordx4 v[4:7], v1, s[44:47], s52 offen offset:0 sc1
v_mfma_f32_16x16x32_bf16 v[184:187], v[44:47], v[20:23], v[184:187]
ds_read_b128 v[80:83], v2 offset:16384
v_mfma_f32_16x16x32_bf16 v[188:191], v[48:51], v[20:23], v[188:191]
v_mfma_f32_16x16x32_bf16 v[192:195], v[52:55], v[20:23], v[192:195]
ds_read_b128 v[84:87], v2 offset:17408
v_mfma_f32_16x16x32_bf16 v[196:199], v[36:39], v[24:27], v[196:199]
buffer_load_dwordx4 v[8:11], v1, s[44:47], s53 offen offset:0 sc1
v_mfma_f32_16x16x32_bf16 v[200:203], v[40:43], v[24:27], v[200:203]
ds_read_b128 v[88:91], v2 offset:18432
v_mfma_f32_16x16x32_bf16 v[204:207], v[44:47], v[24:27], v[204:207]
v_mfma_f32_16x16x32_bf16 v[208:211], v[48:51], v[24:27], v[208:211]
ds_read_b128 v[92:95], v2 offset:19456
v_mfma_f32_16x16x32_bf16 v[212:215], v[52:55], v[24:27], v[212:215]
v_mfma_f32_16x16x32_bf16 v[216:219], v[36:39], v[28:31], v[216:219]
buffer_load_dwordx4 v[12:15], v1, s[44:47], s54 offen offset:0 sc1
v_mfma_f32_16x16x32_bf16 v[220:223], v[40:43], v[28:31], v[220:223]
v_mfma_f32_16x16x32_bf16 v[224:227], v[44:47], v[28:31], v[224:227]
v_mfma_f32_16x16x32_bf16 v[228:231], v[48:51], v[28:31], v[228:231]
v_mfma_f32_16x16x32_bf16 v[232:235], v[52:55], v[28:31], v[232:235]
v_mfma_f32_16x16x32_bf16 v[236:239], v[36:39], v[32:35], v[236:239]
buffer_load_dwordx4 v[16:19], v1, s[44:47], s55 offen offset:0 sc1
v_mfma_f32_16x16x32_bf16 v[240:243], v[40:43], v[32:35], v[240:243]
v_mfma_f32_16x16x32_bf16 v[244:247], v[44:47], v[32:35], v[244:247]
v_mfma_f32_16x16x32_bf16 v[248:251], v[48:51], v[32:35], v[248:251]
v_mfma_f32_16x16x32_bf16 v[252:255], v[52:55], v[32:35], v[252:255]
s_waitcnt vmcnt(8) lgkmcnt(0)
.p2align 3
v_mfma_f32_16x16x32_bf16 v[176:179], v[76:79], v[116:119], v[176:179]
ds_read_b128 v[96:99], v2 offset:20480
s_sub_u32 s17, s16, 1
s_and_b32 s17, s17, 3
s_mul_i32 s18, s17, 35840
s_cmp_ge_u32 s17, 2
s_cselect_b32 s27, 2048, 0
s_add_u32 s18, s18, s27
s_cmp_eq_u32 s17, 3
s_cselect_b32 s18, 104448, s18
s_add_u32 s18, s18, 0
v_add_u32 v136, s18, v1
v_mfma_f32_16x16x32_bf16 v[180:183], v[80:83], v[116:119], v[180:183]
buffer_load_dwordx4 v[20:23], v1, s[44:47], s52 offen offset:2048 sc1
s_sub_u32 s17, s16, 2
s_and_b32 s17, s17, 3
s_mul_i32 s18, s17, 35840
s_cmp_ge_u32 s17, 2
s_cselect_b32 s27, 2048, 0
s_add_u32 s18, s18, s27
s_cmp_eq_u32 s17, 3
s_cselect_b32 s18, 104448, s18
s_add_u32 s18, s18, 5120
v_add_u32 v137, s18, v1
v_mfma_f32_16x16x32_bf16 v[184:187], v[84:87], v[116:119], v[184:187]
ds_read_b128 v[100:103], v2 offset:21504
s_sub_u32 s17, s16, 3
s_and_b32 s17, s17, 3
s_mul_i32 s18, s17, 35840
s_cmp_ge_u32 s17, 2
s_cselect_b32 s27, 2048, 0
s_add_u32 s18, s18, s27
s_cmp_eq_u32 s17, 3
s_cselect_b32 s18, 104448, s18
s_add_u32 s18, s18, 10240
v_add_u32 v138, s18, v1
v_mfma_f32_16x16x32_bf16 v[188:191], v[88:91], v[116:119], v[188:191]
v_and_b32 v148, 15, v0
v_mfma_f32_16x16x32_bf16 v[192:195], v[92:95], v[116:119], v[192:195]
ds_read_b128 v[104:107], v2 offset:22528
v_lshrrev_b32 v149, 4, v0
v_mfma_f32_16x16x32_bf16 v[196:199], v[76:79], v[120:123], v[196:199]
buffer_load_dwordx4 v[24:27], v1, s[44:47], s53 offen offset:2048 sc1
s_lshl_b32 s17, s16, 4
v_mfma_f32_16x16x32_bf16 v[200:203], v[80:83], v[120:123], v[200:203]
ds_read_b128 v[108:111], v2 offset:23552
v_add_u32 v139, s17, v148
v_mfma_f32_16x16x32_bf16 v[204:207], v[84:87], v[120:123], v[204:207]
v_mul_u32_u24 v139, 320, v139
v_mfma_f32_16x16x32_bf16 v[208:211], v[88:91], v[120:123], v[208:211]
ds_read_b128 v[112:115], v2 offset:24576
v_bfe_u32 v150, v148, 1, 2
v_mfma_f32_16x16x32_bf16 v[212:215], v[92:95], v[120:123], v[212:215]
v_xor_b32 v150, v150, v149
v_mfma_f32_16x16x32_bf16 v[216:219], v[76:79], v[124:127], v[216:219]
buffer_load_dwordx4 v[28:31], v1, s[44:47], s54 offen offset:2048 sc1
v_lshl_add_u32 v139, v150, 4, v139
v_mfma_f32_16x16x32_bf16 v[220:223], v[80:83], v[124:127], v[220:223]
v_add_u32 v139, 135168, v139
v_mfma_f32_16x16x32_bf16 v[224:227], v[84:87], v[124:127], v[224:227]
s_lshl_b32 s17, s16, 6
v_mfma_f32_16x16x32_bf16 v[228:231], v[88:91], v[124:127], v[228:231]
s_add_u32 s17, s17, 163328
v_mfma_f32_16x16x32_bf16 v[232:235], v[92:95], v[124:127], v[232:235]
v_lshl_add_u32 v150, v148, 2, s17
v_mfma_f32_16x16x32_bf16 v[236:239], v[76:79], v[128:131], v[236:239]
buffer_load_dwordx4 v[32:35], v1, s[44:47], s55 offen offset:2048 sc1
s_add_u32 s52, s52, 4096
s_add_u32 s53, s53, 4096
s_add_u32 s54, s54, 4096
s_add_u32 s55, s55, 4096
ds_read_b32 v140, v150
v_mfma_f32_16x16x32_bf16 v[240:243], v[80:83], v[128:131], v[240:243]
s_add_u32 s48, s48, 15360
v_mfma_f32_16x16x32_bf16 v[244:247], v[84:87], v[128:131], v[244:247]
v_mul_u32_u24 v141, 176, v148
v_mfma_f32_16x16x32_bf16 v[248:251], v[88:91], v[128:131], v[248:251]
v_lshl_add_u32 v141, v149, 3, v141
v_mfma_f32_16x16x32_bf16 v[252:255], v[92:95], v[128:131], v[252:255]
v_add_u32 v141, s48, v141
s_waitcnt vmcnt(8) lgkmcnt(0)
.p2align 3
v_mfma_f32_16x16x32_bf16 v[176:179], v[96:99], v[56:59], v[176:179]
ds_read_b128 v[156:159], v2 offset:25600
v_add_u32 v148, 0, v0
v_mul_u32_u24 v149, 6554, v148
v_mfma_f32_16x16x32_bf16 v[180:183], v[100:103], v[56:59], v[180:183]
v_lshrrev_b32 v149, 16, v149
v_mul_u32_u24 v150, 10, v149
v_mfma_f32_16x16x32_bf16 v[184:187], v[104:107], v[56:59], v[184:187]
ds_read_b128 v[160:163], v2 offset:26624
v_sub_u32 v150, v148, v150
v_mfma_f32_16x16x32_bf16 v[188:191], v[108:111], v[56:59], v[188:191]
v_lshlrev_b32 v150, 4, v150
v_mul_u32_u24 v151, 176, v149
v_mfma_f32_16x16x32_bf16 v[192:195], v[112:115], v[56:59], v[192:195]
ds_read_b128 v[164:167], v2 offset:27648
v_add3_u32 v142, v151, v150, s48
v_mfma_f32_16x16x32_bf16 v[196:199], v[96:99], v[60:63], v[196:199]
v_mul_u32_u24 v149, 0x14000, v149
v_add_u32 v145, v149, v150
v_mfma_f32_16x16x32_bf16 v[200:203], v[100:103], v[60:63], v[200:203]
ds_read_b128 v[168:171], v2 offset:28672
v_add_u32 v148, 64, v0
v_mfma_f32_16x16x32_bf16 v[204:207], v[104:107], v[60:63], v[204:207]
v_mul_u32_u24 v149, 6554, v148
v_lshrrev_b32 v149, 16, v149
v_mfma_f32_16x16x32_bf16 v[208:211], v[108:111], v[60:63], v[208:211]
ds_read_b128 v[172:175], v2 offset:29696
v_mul_u32_u24 v150, 10, v149
v_mfma_f32_16x16x32_bf16 v[212:215], v[112:115], v[60:63], v[212:215]
v_sub_u32 v150, v148, v150
v_lshlrev_b32 v150, 4, v150
v_mfma_f32_16x16x32_bf16 v[216:219], v[96:99], v[64:67], v[216:219]
ds_write_b32 v3, v3 offset:28
v_mul_u32_u24 v151, 176, v149
v_add3_u32 v143, v151, v150, s48
v_mfma_f32_16x16x32_bf16 v[220:223], v[100:103], v[64:67], v[220:223]
v_mul_u32_u24 v149, 0x14000, v149
v_mfma_f32_16x16x32_bf16 v[224:227], v[104:107], v[64:67], v[224:227]
v_add_u32 v146, v149, v150
v_add_u32 v148, 128, v0
v_mfma_f32_16x16x32_bf16 v[228:231], v[108:111], v[64:67], v[228:231]
v_mul_u32_u24 v149, 6554, v148
v_mfma_f32_16x16x32_bf16 v[232:235], v[112:115], v[64:67], v[232:235]
v_lshrrev_b32 v149, 16, v149
v_mul_u32_u24 v150, 10, v149
v_mfma_f32_16x16x32_bf16 v[236:239], v[96:99], v[68:71], v[236:239]
v_sub_u32 v150, v148, v150
v_mfma_f32_16x16x32_bf16 v[240:243], v[100:103], v[68:71], v[240:243]
v_lshlrev_b32 v150, 4, v150
v_mul_u32_u24 v151, 176, v149
v_mfma_f32_16x16x32_bf16 v[244:247], v[104:107], v[68:71], v[244:247]
v_add3_u32 v144, v151, v150, s48
v_mfma_f32_16x16x32_bf16 v[248:251], v[108:111], v[68:71], v[248:251]
v_mul_u32_u24 v149, 0x14000, v149
v_add_u32 v147, v149, v150
v_mfma_f32_16x16x32_bf16 v[252:255], v[112:115], v[68:71], v[252:255]
s_mov_b32 s40, s84
s_mov_b32 s41, s85
s_mov_b32 s42, 2621440
s_mov_b32 s43, 0x20000
s_lshl_b32 s17, s31, 10
s_lshl_b32 s18, s20, 2
s_add_u32 s17, s17, s18
s_add_u32 s17, s17, s16
s_mul_i32 s17, s17, 1280
s_mul_i32 s18, s15, 160
s_add_u32 s49, s17, s18
s_cmp_ge_u32 s16, 2
s_cbranch_scc1 L_g_last12
s_waitcnt vmcnt(4) lgkmcnt(0)
.p2align 3
v_mfma_f32_16x16x32_bf16 v[176:179], v[156:159], v[4:7], v[176:179]
ds_read_b128 v[36:39], v2 offset:30720
v_mfma_f32_16x16x32_bf16 v[180:183], v[160:163], v[4:7], v[180:183]
v_mfma_f32_16x16x32_bf16 v[184:187], v[164:167], v[4:7], v[184:187]
ds_read_b128 v[40:43], v2 offset:31744
v_mfma_f32_16x16x32_bf16 v[188:191], v[168:171], v[4:7], v[188:191]
v_mfma_f32_16x16x32_bf16 v[192:195], v[172:175], v[4:7], v[192:195]
ds_read_b128 v[44:47], v2 offset:32768
v_mfma_f32_16x16x32_bf16 v[196:199], v[156:159], v[8:11], v[196:199]
v_mfma_f32_16x16x32_bf16 v[200:203], v[160:163], v[8:11], v[200:203]
ds_read_b128 v[48:51], v2 offset:33792
v_mfma_f32_16x16x32_bf16 v[204:207], v[164:167], v[8:11], v[204:207]
v_mfma_f32_16x16x32_bf16 v[208:211], v[168:171], v[8:11], v[208:211]
ds_read_b128 v[52:55], v2 offset:34816
v_mfma_f32_16x16x32_bf16 v[212:215], v[172:175], v[8:11], v[212:215]
v_mfma_f32_16x16x32_bf16 v[216:219], v[156:159], v[12:15], v[216:219]
v_mfma_f32_16x16x32_bf16 v[220:223], v[160:163], v[12:15], v[220:223]
v_mfma_f32_16x16x32_bf16 v[224:227], v[164:167], v[12:15], v[224:227]
v_mfma_f32_16x16x32_bf16 v[228:231], v[168:171], v[12:15], v[228:231]
v_mfma_f32_16x16x32_bf16 v[232:235], v[172:175], v[12:15], v[232:235]
v_mfma_f32_16x16x32_bf16 v[236:239], v[156:159], v[16:19], v[236:239]
v_mfma_f32_16x16x32_bf16 v[240:243], v[160:163], v[16:19], v[240:243]
v_mfma_f32_16x16x32_bf16 v[244:247], v[164:167], v[16:19], v[244:247]
v_mfma_f32_16x16x32_bf16 v[248:251], v[168:171], v[16:19], v[248:251]
v_mfma_f32_16x16x32_bf16 v[252:255], v[172:175], v[16:19], v[252:255]
s_waitcnt vmcnt(0) lgkmcnt(0)
.p2align 3
v_mfma_f32_16x16x32_bf16 v[196:199], v[36:39], v[24:27], v[196:199]
v_mfma_f32_16x16x32_bf16 v[200:203], v[40:43], v[24:27], v[200:203]
v_mfma_f32_16x16x32_bf16 v[204:207], v[44:47], v[24:27], v[204:207]
v_mfma_f32_16x16x32_bf16 v[208:211], v[48:51], v[24:27], v[208:211]
v_mfma_f32_16x16x32_bf16 v[212:215], v[52:55], v[24:27], v[212:215]
v_mfma_f32_16x16x32_bf16 v[216:219], v[36:39], v[28:31], v[216:219]
v_mfma_f32_16x16x32_bf16 v[220:223], v[40:43], v[28:31], v[220:223]
v_mfma_f32_16x16x32_bf16 v[224:227], v[44:47], v[28:31], v[224:227]
v_mfma_f32_16x16x32_bf16 v[228:231], v[48:51], v[28:31], v[228:231]
v_mfma_f32_16x16x32_bf16 v[232:235], v[52:55], v[28:31], v[232:235]
v_mfma_f32_16x16x32_bf16 v[236:239], v[36:39], v[32:35], v[236:239]
v_mfma_f32_16x16x32_bf16 v[240:243], v[40:43], v[32:35], v[240:243]
v_mfma_f32_16x16x32_bf16 v[244:247], v[44:47], v[32:35], v[244:247]
v_mfma_f32_16x16x32_bf16 v[248:251], v[48:51], v[32:35], v[248:251]
ds_write_b128 v2, v[196:199] offset:0
v_mfma_f32_16x16x32_bf16 v[252:255], v[52:55], v[32:35], v[252:255]
ds_write_b128 v2, v[200:203] offset:1024
v_mfma_f32_16x16x32_bf16 v[176:179], v[36:39], v[20:23], v[176:179]
ds_write_b128 v2, v[204:207] offset:2048
v_mfma_f32_16x16x32_bf16 v[180:183], v[40:43], v[20:23], v[180:183]
ds_write_b128 v2, v[208:211] offset:3072
v_mfma_f32_16x16x32_bf16 v[184:187], v[44:47], v[20:23], v[184:187]
ds_write_b128 v2, v[212:215] offset:4096
v_mfma_f32_16x16x32_bf16 v[188:191], v[48:51], v[20:23], v[188:191]
ds_write_b128 v2, v[216:219] offset:5120
ds_write_b128 v2, v[220:223] offset:6144
ds_write_b128 v2, v[224:227] offset:7168
v_mfma_f32_16x16x32_bf16 v[192:195], v[52:55], v[20:23], v[192:195]
ds_write_b128 v2, v[228:231] offset:8192
ds_write_b128 v2, v[232:235] offset:9216
ds_write_b128 v2, v[236:239] offset:10240
ds_write_b128 v2, v[240:243] offset:11264
ds_write_b128 v2, v[244:247] offset:12288
ds_write_b128 v2, v[248:251] offset:13312
ds_write_b128 v2, v[252:255] offset:14336
s_branch L_g_p2done
L_g_last12:
s_waitcnt vmcnt(4) lgkmcnt(0)
.p2align 3
v_mfma_f32_16x16x32_bf16 v[196:199], v[156:159], v[8:11], v[196:199]
v_mfma_f32_16x16x32_bf16 v[200:203], v[160:163], v[8:11], v[200:203]
v_mfma_f32_16x16x32_bf16 v[204:207], v[164:167], v[8:11], v[204:207]
v_mfma_f32_16x16x32_bf16 v[208:211], v[168:171], v[8:11], v[208:211]
v_mfma_f32_16x16x32_bf16 v[212:215], v[172:175], v[8:11], v[212:215]
v_mfma_f32_16x16x32_bf16 v[216:219], v[156:159], v[12:15], v[216:219]
v_mfma_f32_16x16x32_bf16 v[220:223], v[160:163], v[12:15], v[220:223]
v_mfma_f32_16x16x32_bf16 v[224:227], v[164:167], v[12:15], v[224:227]
v_mfma_f32_16x16x32_bf16 v[228:231], v[168:171], v[12:15], v[228:231]
v_mfma_f32_16x16x32_bf16 v[232:235], v[172:175], v[12:15], v[232:235]
v_mfma_f32_16x16x32_bf16 v[236:239], v[156:159], v[16:19], v[236:239]
v_mfma_f32_16x16x32_bf16 v[240:243], v[160:163], v[16:19], v[240:243]
v_mfma_f32_16x16x32_bf16 v[244:247], v[164:167], v[16:19], v[244:247]
v_mfma_f32_16x16x32_bf16 v[248:251], v[168:171], v[16:19], v[248:251]
ds_write_b128 v2, v[196:199] offset:0
v_mfma_f32_16x16x32_bf16 v[252:255], v[172:175], v[16:19], v[252:255]
ds_write_b128 v2, v[200:203] offset:1024
v_mfma_f32_16x16x32_bf16 v[176:179], v[156:159], v[4:7], v[176:179]
ds_write_b128 v2, v[204:207] offset:2048
v_mfma_f32_16x16x32_bf16 v[180:183], v[160:163], v[4:7], v[180:183]
ds_write_b128 v2, v[208:211] offset:3072
v_mfma_f32_16x16x32_bf16 v[184:187], v[164:167], v[4:7], v[184:187]
ds_write_b128 v2, v[212:215] offset:4096
v_mfma_f32_16x16x32_bf16 v[188:191], v[168:171], v[4:7], v[188:191]
ds_write_b128 v2, v[216:219] offset:5120
ds_write_b128 v2, v[220:223] offset:6144
ds_write_b128 v2, v[224:227] offset:7168
v_mfma_f32_16x16x32_bf16 v[192:195], v[172:175], v[4:7], v[192:195]
ds_write_b128 v2, v[228:231] offset:8192
ds_write_b128 v2, v[232:235] offset:9216
ds_write_b128 v2, v[236:239] offset:10240
ds_write_b128 v2, v[240:243] offset:11264
ds_write_b128 v2, v[244:247] offset:12288
ds_write_b128 v2, v[248:251] offset:13312
ds_write_b128 v2, v[252:255] offset:14336
L_g_p2done:
v_mul_f32 v140, v140, v140
s_waitcnt vmcnt(0) lgkmcnt(0)
v_mov_b32 v96, 1
s_mov_b64 exec, 1
ds_add_u32 v3, v96 offset:84
s_mov_b64 exec, -1
s_mov_b32 s19, 0
L_sp58:
ds_read_b32 v96, v3 offset:84
s_waitcnt lgkmcnt(0)
v_readfirstlane_b32 s27, v96
s_add_u32 s19, s19, 1
s_cmp_gt_u32 s19, 200000
s_cbranch_scc1 L_sp58d
s_cmp_ge_u32 s27, 4
s_cbranch_scc1 L_sp58d

s_branch L_sp58
L_sp58d:
ds_read_b128 v[4:7], v136 offset:0
ds_read_b128 v[8:11], v137 offset:0
ds_read_b128 v[12:15], v138 offset:0
ds_read_b128 v[20:23], v136 offset:1024
ds_read_b128 v[24:27], v137 offset:1024
ds_read_b128 v[28:31], v138 offset:1024
ds_read_b128 v[36:39], v136 offset:2048
ds_read_b128 v[40:43], v137 offset:2048
ds_read_b128 v[44:47], v138 offset:2048
ds_read_b128 v[56:59], v136 offset:3072
ds_read_b128 v[60:63], v137 offset:3072
ds_read_b128 v[64:67], v138 offset:3072
ds_read_b128 v[76:79], v136 offset:4096
ds_read_b128 v[80:83], v137 offset:4096
ds_read_b128 v[84:87], v138 offset:4096
ds_read_b32 v96, v3 offset:88
s_waitcnt lgkmcnt(13)
v_pk_add_f32 v[176:177], v[176:177], v[4:5]
v_pk_add_f32 v[8:9], v[8:9], v[12:13]
v_pk_add_f32 v[178:179], v[178:179], v[6:7]
v_pk_add_f32 v[10:11], v[10:11], v[14:15]
v_pk_add_f32 v[176:177], v[176:177], v[8:9]
v_pk_add_f32 v[178:179], v[178:179], v[10:11]
s_waitcnt lgkmcnt(10)
v_pk_add_f32 v[180:181], v[180:181], v[20:21]
v_pk_add_f32 v[24:25], v[24:25], v[28:29]
v_pk_add_f32 v[182:183], v[182:183], v[22:23]
v_pk_add_f32 v[26:27], v[26:27], v[30:31]
v_pk_add_f32 v[180:181], v[180:181], v[24:25]
v_pk_add_f32 v[182:183], v[182:183], v[26:27]
s_waitcnt lgkmcnt(7)
v_pk_add_f32 v[184:185], v[184:185], v[36:37]
v_pk_add_f32 v[40:41], v[40:41], v[44:45]
v_pk_add_f32 v[186:187], v[186:187], v[38:39]
v_pk_add_f32 v[42:43], v[42:43], v[46:47]
v_pk_add_f32 v[184:185], v[184:185], v[40:41]
v_pk_add_f32 v[186:187], v[186:187], v[42:43]
s_waitcnt lgkmcnt(4)
v_pk_add_f32 v[188:189], v[188:189], v[56:57]
v_pk_add_f32 v[60:61], v[60:61], v[64:65]
v_pk_add_f32 v[190:191], v[190:191], v[58:59]
v_pk_add_f32 v[62:63], v[62:63], v[66:67]
v_pk_add_f32 v[188:189], v[188:189], v[60:61]
v_pk_add_f32 v[190:191], v[190:191], v[62:63]
s_waitcnt lgkmcnt(1)
v_pk_add_f32 v[192:193], v[192:193], v[76:77]
v_pk_add_f32 v[80:81], v[80:81], v[84:85]
v_pk_add_f32 v[194:195], v[194:195], v[78:79]
v_pk_add_f32 v[82:83], v[82:83], v[86:87]
v_pk_add_f32 v[192:193], v[192:193], v[80:81]
v_pk_add_f32 v[194:195], v[194:195], v[82:83]
s_waitcnt lgkmcnt(0)
v_readfirstlane_b32 s27, v96
s_cmp_ge_u32 s27, 4
s_cbranch_scc1 L_g_yok
s_mov_b32 s19, 0
L_sp59:
ds_read_b32 v96, v3 offset:88
s_waitcnt lgkmcnt(0)
v_readfirstlane_b32 s27, v96
s_add_u32 s19, s19, 1
s_cmp_gt_u32 s19, 200000
s_cbranch_scc1 L_sp59d
s_cmp_ge_u32 s27, 4
s_cbranch_scc1 L_sp59d

s_branch L_sp59
L_sp59d:
L_g_yok:
ds_read_b128 v[16:19], v139 offset:0
ds_read_b128 v[32:35], v139 offset:64
ds_read_b128 v[48:51], v139 offset:128
ds_read_b128 v[68:71], v139 offset:192
ds_read_b128 v[88:91], v139 offset:256
s_waitcnt lgkmcnt(4)
v_pk_fma_f32 v[176:177], v[176:177], v[140:141], v[16:17] op_sel_hi:[1,0,1]
v_pk_fma_f32 v[178:179], v[178:179], v[140:141], v[18:19] op_sel_hi:[1,0,1]
v_cvt_pk_bf16_f32 v4, v176, v177
v_cvt_pk_bf16_f32 v5, v178, v179
ds_write_b64 v141, v[4:5] offset:0
s_waitcnt lgkmcnt(4)
v_pk_fma_f32 v[180:181], v[180:181], v[140:141], v[32:33] op_sel_hi:[1,0,1]
v_pk_fma_f32 v[182:183], v[182:183], v[140:141], v[34:35] op_sel_hi:[1,0,1]
v_cvt_pk_bf16_f32 v20, v180, v181
v_cvt_pk_bf16_f32 v21, v182, v183
ds_write_b64 v141, v[20:21] offset:32
s_waitcnt lgkmcnt(4)
v_pk_fma_f32 v[184:185], v[184:185], v[140:141], v[48:49] op_sel_hi:[1,0,1]
v_pk_fma_f32 v[186:187], v[186:187], v[140:141], v[50:51] op_sel_hi:[1,0,1]
v_cvt_pk_bf16_f32 v36, v184, v185
v_cvt_pk_bf16_f32 v37, v186, v187
ds_write_b64 v141, v[36:37] offset:64
s_waitcnt lgkmcnt(4)
v_pk_fma_f32 v[188:189], v[188:189], v[140:141], v[68:69] op_sel_hi:[1,0,1]
v_pk_fma_f32 v[190:191], v[190:191], v[140:141], v[70:71] op_sel_hi:[1,0,1]
v_cvt_pk_bf16_f32 v56, v188, v189
v_cvt_pk_bf16_f32 v57, v190, v191
ds_write_b64 v141, v[56:57] offset:96
s_waitcnt lgkmcnt(4)
v_pk_fma_f32 v[192:193], v[192:193], v[140:141], v[88:89] op_sel_hi:[1,0,1]
v_pk_fma_f32 v[194:195], v[194:195], v[140:141], v[90:91] op_sel_hi:[1,0,1]
v_cvt_pk_bf16_f32 v76, v192, v193
v_cvt_pk_bf16_f32 v77, v194, v195
ds_write_b64 v141, v[76:77] offset:128
s_waitcnt lgkmcnt(0)
ds_read_b128 v[96:99], v142
ds_read_b128 v[100:103], v143
ds_read_b128 v[104:107], v144
s_waitcnt lgkmcnt(2)
buffer_store_dwordx4 v[96:99], v145, s[40:43], s49 offen sc1
s_waitcnt lgkmcnt(1)
buffer_store_dwordx4 v[100:103], v146, s[40:43], s49 offen sc1
s_mov_b32 exec_hi, 0
s_waitcnt lgkmcnt(0)
buffer_store_dwordx4 v[104:107], v147, s[40:43], s49 offen sc1
s_mov_b64 exec, -1
L_end:

s_endpgm
.fill 512, 4, 0xbf810000
.section .rodata,"a"
.p2align 6
.amdhsa_kernel parallel_sum__spectral_fnet__dense_activation_squared_relu__prompt_kernel
  .amdhsa_next_free_vgpr 256
  .amdhsa_next_free_sgpr 102
  .amdhsa_accum_offset 256
  .amdhsa_group_segment_fixed_size 0
  .amdhsa_kernarg_size 104
  .amdhsa_user_sgpr_count 2
  .amdhsa_user_sgpr_kernarg_segment_ptr 1
  .amdhsa_system_sgpr_workgroup_id_x 1
.end_amdhsa_kernel
```
